```python
import torch

def _softmax(x, axis=-1):
    return torch.softmax(x, dim=axis)
def _gelu(x):
    return torch.nn.functional.gelu(x, approximate="tanh")
def _silu(x):
    return torch.nn.functional.silu(x)
def _sigmoid(x):
    return torch.sigmoid(x)
def _layernorm(x, axis=-1, eps=1e-5):
    m = x.mean(dim=axis, keepdim=True)
    v = x.var(dim=axis, keepdim=True, unbiased=False)
    return (x - m) / torch.sqrt(v + eps)
def _scatter_add(tgt, idx, src, axis=0):
    return tgt.clone().index_add_(axis, idx, src)
def _segment_sum(src, seg, n):
    out = torch.zeros((n,) + src.shape[1:], dtype=src.dtype)
    return out.index_add_(0, seg, src)
def _pad(x, pw):
    flat = tuple(v for pair in reversed(pw) for v in pair)
    return torch.nn.functional.pad(x, flat)

kernel_name = 'sequential_preLN__mha_block__mixer_channel_mlp__prompt'

def setup_inputs():

    _w = (lambda a: (lambda t: t.to(torch.bfloat16) if t.is_floating_point() else t)(torch.as_tensor(a)))
    def _A_setup():
        B, S, D, H = 1, 2048, 512, 32
        return {
            "x": _w((lambda *s: torch.randn(*s, dtype=torch.bfloat16) * 0.05)(B, S, D)),
            "wqkv": _w((lambda *s: torch.randn(*s, dtype=torch.bfloat16) * 0.05)(D, 3 * D)),
            "wo": _w((lambda *s: torch.randn(*s, dtype=torch.bfloat16) * 0.05)(D, D)),
        }
    _A_in = _A_setup()

    def _B_setup():
        B, S, D, F = 1, 2048, 512, 1792
        return {
            "x": _w((lambda *s: torch.randn(*s, dtype=torch.bfloat16) * 0.05)(B, S, D)),
            "w1": _w((lambda *s: torch.randn(*s, dtype=torch.bfloat16) * 3.2)(D, F) * (D ** -0.5)),
            "b1": _w((lambda *s: torch.randn(*s, dtype=torch.bfloat16) * 1.6)(F)),
            "w2": _w((lambda *s: torch.randn(*s, dtype=torch.bfloat16) * 0.05)(F, D) * (F ** -0.5)),
            "b2": _w((lambda *s: torch.randn(*s, dtype=torch.bfloat16) * 0.1)(D)),
        }
    _B_in = _B_setup()

    return {
        "A_x": _A_in["x"],
        "A_wqkv": _A_in["wqkv"],
        "A_wo": _A_in["wo"],
        "B_x": _B_in["x"],
        "B_w1": _B_in["w1"],
        "B_b1": _B_in["b1"],
        "B_w2": _B_in["w2"],
        "B_b2": _B_in["b2"],
    }

def reference(A_x, A_wqkv, A_wo, B_x, B_w1, B_b1, B_w2, B_b2):
    def _A_ref(x, wqkv, wo):
        B, S, D = x.shape
        H = 32
        Dh = D // H
        qkv = (lambda x, *d: x.permute(*d))((x @ wqkv).reshape(B, S, 3, H, Dh), 2, 0, 3, 1, 4)
        q, k, v = qkv[0], qkv[1], qkv[2]
        scores = torch.einsum("bhqd,bhkd->bhqk", q, k) * (Dh ** -0.5)
        p = _softmax(scores, axis=-1)
        o = torch.einsum("bhqk,bhkd->bhqd", p, v)
        return (lambda x, *d: x.permute(*d))(o, 0, 2, 1, 3).reshape(B, S, D) @ wo

    def _B_ref(x, w1, b1, w2, b2):
        y = _layernorm(x, axis=-1)
        h = _gelu(torch.einsum("bsd,df->bsf", y, w1) + b1)
        return torch.einsum("bsf,fd->bsd", h, w2) + b2

    x = A_x
    h = x + _A_ref(_layernorm(x, axis=-1), A_wqkv, A_wo)
    h2 = h + _B_ref(_layernorm(h, axis=-1), B_w1, B_b1, B_w2, B_b2)
    return h2
```

```asm
; @launch kernel=k1_qkv_kernel grid=(256,1,1) block=(768,1,1) lds=134656
; @launch kernel=km_fused_kernel grid=(256,1,1) block=(512,1,1) lds=142400
.amdgcn_target "amdgcn-amd-amdhsa--gfx950"
.text
.globl k1_qkv_kernel
.p2align 8
.type k1_qkv_kernel,@function
k1_qkv_kernel:
    s_load_dwordx4 s[4:7], s[0:1], 0
    s_load_dwordx2 s[8:9], s[0:1], 80
    s_cmp_ge_u32 s2, 256
    s_cbranch_scc1 K1_END
    v_lshrrev_b32 v2, 6, v0
    v_and_b32 v1, 63, v0
    v_readfirstlane_b32 s24, v2
    s_and_b32 s26, s2, 7
    s_lshr_b32 s27, s2, 3
    s_and_b32 s25, s24, 3
    s_and_b32 s31, s26, 3
    s_lshl_b32 s31, s31, 3
    s_and_b32 s32, s27, 7
    s_add_u32 s28, s31, s32
    s_lshr_b32 s31, s26, 2
    s_lshl_b32 s31, s31, 2
    s_lshr_b32 s29, s27, 3
    s_lshl_b32 s30, s29, 1
    s_add_u32 s30, s30, s32
    s_add_u32 s30, s30, s26
    s_add_u32 s29, s29, s31
    s_and_b32 s39, s25, 1
    s_lshr_b32 s40, s25, 1
    s_cmp_lt_u32 s24, 4
    s_cbranch_scc1 K1_COMPUTE
    s_cmp_ge_u32 s24, 8
    s_cbranch_scc1 K1_STATS
    s_mul_i32 s34, s25, 24576
    s_lshl_b32 s31, s29, 7
    s_add_u32 s34, s34, s31
    s_lshl_b32 s35, s25, 10
    s_add_u32 s36, s35, 32768
    v_bfe_u32 v2, v1, 2, 3
    v_mul_u32_u24 v2, 3072, v2
    v_and_b32 v3, 3, v1
    v_lshl_add_u32 v2, v3, 4, v2
    v_lshrrev_b32 v3, 5, v1
    v_lshl_add_u32 v7, v3, 6, v2
    s_waitcnt lgkmcnt(0)
    s_mov_b32 s16, s6
    s_and_b32 s17, s7, 0xffff
    s_mov_b32 s18, 1572864
    s_mov_b32 s19, 0x20000
    s_lshl_b32 s33, s28, 16
    s_lshl_b32 s31, s25, 13
    s_add_u32 s33, s33, s31
    s_lshl_b32 s31, s39, 2
    v_lshrrev_b32 v2, 4, v1
    v_or_b32 v2, s31, v2
    v_and_b32 v3, 7, v1
    v_xor_b32 v2, v2, v3
    v_lshlrev_b32 v2, 4, v2
    v_lshrrev_b32 v3, 3, v1
    v_lshlrev_b32 v3, 10, v3
    v_add_u32 v8, v2, v3
    s_mov_b32 s12, s4
    s_and_b32 s13, s5, 0xffff
    s_mov_b32 s14, 2097152
    s_mov_b32 s15, 0x20000
    s_add_u32 s31, s30, 0
    s_and_b32 s31, s31, 7
    s_lshl_b32 s37, s31, 7
    s_add_u32 s37, s37, s33
    s_add_u32 m0, s35, 0
    s_add_u32 s32, s37, 0
    buffer_load_dwordx4 v8, s[12:15], s32 offen lds
    s_add_u32 m0, s35, 4096
    s_add_u32 s32, s37, 32768
    buffer_load_dwordx4 v8, s[12:15], s32 offen lds
    s_add_u32 s31, s30, 0
    s_and_b32 s31, s31, 7
    s_mul_i32 s38, s31, 196608
    s_add_u32 s38, s38, s34
    s_add_u32 m0, s36, 0
    s_add_u32 s32, s38, 0
    buffer_load_dwordx4 v7, s[16:19], s32 offen lds
    s_add_u32 m0, s36, 4096
    s_add_u32 s32, s38, 98304
    buffer_load_dwordx4 v7, s[16:19], s32 offen lds
    s_add_u32 m0, s36, 8192
    s_add_u32 s32, s38, 1024
    buffer_load_dwordx4 v7, s[16:19], s32 offen lds
    s_add_u32 m0, s36, 12288
    s_add_u32 s32, s38, 99328
    buffer_load_dwordx4 v7, s[16:19], s32 offen lds
    s_add_u32 m0, s36, 16384
    s_add_u32 s32, s38, 2048
    buffer_load_dwordx4 v7, s[16:19], s32 offen lds
    s_add_u32 m0, s36, 20480
    s_add_u32 s32, s38, 100352
    buffer_load_dwordx4 v7, s[16:19], s32 offen lds
    s_add_u32 s31, s30, 1
    s_and_b32 s31, s31, 7
    s_lshl_b32 s37, s31, 7
    s_add_u32 s37, s37, s33
    s_add_u32 m0, s35, 8192
    s_add_u32 s32, s37, 0
    buffer_load_dwordx4 v8, s[12:15], s32 offen lds
    s_add_u32 m0, s35, 12288
    s_add_u32 s32, s37, 32768
    buffer_load_dwordx4 v8, s[12:15], s32 offen lds
    s_add_u32 s31, s30, 1
    s_and_b32 s31, s31, 7
    s_mul_i32 s38, s31, 196608
    s_add_u32 s38, s38, s34
    s_add_u32 m0, s36, 24576
    s_add_u32 s32, s38, 0
    buffer_load_dwordx4 v7, s[16:19], s32 offen lds
    s_add_u32 m0, s36, 28672
    s_add_u32 s32, s38, 98304
    buffer_load_dwordx4 v7, s[16:19], s32 offen lds
    s_add_u32 m0, s36, 32768
    s_add_u32 s32, s38, 1024
    buffer_load_dwordx4 v7, s[16:19], s32 offen lds
    s_add_u32 m0, s36, 36864
    s_add_u32 s32, s38, 99328
    buffer_load_dwordx4 v7, s[16:19], s32 offen lds
    s_add_u32 m0, s36, 40960
    s_add_u32 s32, s38, 2048
    buffer_load_dwordx4 v7, s[16:19], s32 offen lds
    s_add_u32 m0, s36, 45056
    s_add_u32 s32, s38, 100352
    buffer_load_dwordx4 v7, s[16:19], s32 offen lds
    s_waitcnt vmcnt(8)
    s_barrier
    s_add_u32 s31, s30, 2
    s_and_b32 s31, s31, 7
    s_lshl_b32 s37, s31, 7
    s_add_u32 s37, s37, s33
    s_add_u32 m0, s35, 16384
    s_add_u32 s32, s37, 0
    buffer_load_dwordx4 v8, s[12:15], s32 offen lds
    s_add_u32 m0, s35, 20480
    s_add_u32 s32, s37, 32768
    buffer_load_dwordx4 v8, s[12:15], s32 offen lds
    s_add_u32 s31, s30, 2
    s_and_b32 s31, s31, 7
    s_mul_i32 s38, s31, 196608
    s_add_u32 s38, s38, s34
    s_add_u32 m0, s36, 49152
    s_add_u32 s32, s38, 0
    buffer_load_dwordx4 v7, s[16:19], s32 offen lds
    s_add_u32 m0, s36, 53248
    s_add_u32 s32, s38, 98304
    buffer_load_dwordx4 v7, s[16:19], s32 offen lds
    s_add_u32 m0, s36, 57344
    s_add_u32 s32, s38, 1024
    buffer_load_dwordx4 v7, s[16:19], s32 offen lds
    s_add_u32 m0, s36, 61440
    s_add_u32 s32, s38, 99328
    buffer_load_dwordx4 v7, s[16:19], s32 offen lds
    s_add_u32 m0, s36, 65536
    s_add_u32 s32, s38, 2048
    buffer_load_dwordx4 v7, s[16:19], s32 offen lds
    s_add_u32 m0, s36, 69632
    s_add_u32 s32, s38, 100352
    buffer_load_dwordx4 v7, s[16:19], s32 offen lds
    s_add_u32 s31, s30, 3
    s_and_b32 s31, s31, 7
    s_lshl_b32 s37, s31, 7
    s_add_u32 s37, s37, s33
    s_add_u32 m0, s35, 24576
    s_add_u32 s32, s37, 0
    buffer_load_dwordx4 v8, s[12:15], s32 offen lds
    s_add_u32 m0, s35, 28672
    s_add_u32 s32, s37, 32768
    buffer_load_dwordx4 v8, s[12:15], s32 offen lds
    s_add_u32 s31, s30, 3
    s_and_b32 s31, s31, 7
    s_mul_i32 s38, s31, 196608
    s_add_u32 s38, s38, s34
    s_add_u32 m0, s36, 73728
    s_add_u32 s32, s38, 0
    buffer_load_dwordx4 v7, s[16:19], s32 offen lds
    s_add_u32 m0, s36, 77824
    s_add_u32 s32, s38, 98304
    buffer_load_dwordx4 v7, s[16:19], s32 offen lds
    s_add_u32 m0, s36, 81920
    s_add_u32 s32, s38, 1024
    buffer_load_dwordx4 v7, s[16:19], s32 offen lds
    s_add_u32 m0, s36, 86016
    s_add_u32 s32, s38, 99328
    buffer_load_dwordx4 v7, s[16:19], s32 offen lds
    s_add_u32 m0, s36, 90112
    s_add_u32 s32, s38, 2048
    buffer_load_dwordx4 v7, s[16:19], s32 offen lds
    s_add_u32 m0, s36, 94208
    s_add_u32 s32, s38, 100352
    buffer_load_dwordx4 v7, s[16:19], s32 offen lds
    s_waitcnt vmcnt(16)
    s_barrier
    s_add_u32 s31, s30, 4
    s_and_b32 s31, s31, 7
    s_lshl_b32 s37, s31, 7
    s_add_u32 s37, s37, s33
    s_add_u32 m0, s35, 0
    s_add_u32 s32, s37, 0
    buffer_load_dwordx4 v8, s[12:15], s32 offen lds
    s_add_u32 m0, s35, 4096
    s_add_u32 s32, s37, 32768
    buffer_load_dwordx4 v8, s[12:15], s32 offen lds
    s_add_u32 s31, s30, 4
    s_and_b32 s31, s31, 7
    s_mul_i32 s38, s31, 196608
    s_add_u32 s38, s38, s34
    s_add_u32 m0, s36, 0
    s_add_u32 s32, s38, 0
    buffer_load_dwordx4 v7, s[16:19], s32 offen lds
    s_add_u32 m0, s36, 4096
    s_add_u32 s32, s38, 98304
    buffer_load_dwordx4 v7, s[16:19], s32 offen lds
    s_add_u32 m0, s36, 8192
    s_add_u32 s32, s38, 1024
    buffer_load_dwordx4 v7, s[16:19], s32 offen lds
    s_add_u32 m0, s36, 12288
    s_add_u32 s32, s38, 99328
    buffer_load_dwordx4 v7, s[16:19], s32 offen lds
    s_add_u32 m0, s36, 16384
    s_add_u32 s32, s38, 2048
    buffer_load_dwordx4 v7, s[16:19], s32 offen lds
    s_add_u32 m0, s36, 20480
    s_add_u32 s32, s38, 100352
    buffer_load_dwordx4 v7, s[16:19], s32 offen lds
    s_waitcnt vmcnt(16)
    s_barrier
    s_add_u32 s31, s30, 5
    s_and_b32 s31, s31, 7
    s_lshl_b32 s37, s31, 7
    s_add_u32 s37, s37, s33
    s_add_u32 m0, s35, 8192
    s_add_u32 s32, s37, 0
    buffer_load_dwordx4 v8, s[12:15], s32 offen lds
    s_add_u32 m0, s35, 12288
    s_add_u32 s32, s37, 32768
    buffer_load_dwordx4 v8, s[12:15], s32 offen lds
    s_add_u32 s31, s30, 5
    s_and_b32 s31, s31, 7
    s_mul_i32 s38, s31, 196608
    s_add_u32 s38, s38, s34
    s_add_u32 m0, s36, 24576
    s_add_u32 s32, s38, 0
    buffer_load_dwordx4 v7, s[16:19], s32 offen lds
    s_add_u32 m0, s36, 28672
    s_add_u32 s32, s38, 98304
    buffer_load_dwordx4 v7, s[16:19], s32 offen lds
    s_add_u32 m0, s36, 32768
    s_add_u32 s32, s38, 1024
    buffer_load_dwordx4 v7, s[16:19], s32 offen lds
    s_add_u32 m0, s36, 36864
    s_add_u32 s32, s38, 99328
    buffer_load_dwordx4 v7, s[16:19], s32 offen lds
    s_add_u32 m0, s36, 40960
    s_add_u32 s32, s38, 2048
    buffer_load_dwordx4 v7, s[16:19], s32 offen lds
    s_add_u32 m0, s36, 45056
    s_add_u32 s32, s38, 100352
    buffer_load_dwordx4 v7, s[16:19], s32 offen lds
    s_waitcnt vmcnt(16)
    s_barrier
    s_add_u32 s31, s30, 6
    s_and_b32 s31, s31, 7
    s_lshl_b32 s37, s31, 7
    s_add_u32 s37, s37, s33
    s_add_u32 m0, s35, 16384
    s_add_u32 s32, s37, 0
    buffer_load_dwordx4 v8, s[12:15], s32 offen lds
    s_add_u32 m0, s35, 20480
    s_add_u32 s32, s37, 32768
    buffer_load_dwordx4 v8, s[12:15], s32 offen lds
    s_add_u32 s31, s30, 6
    s_and_b32 s31, s31, 7
    s_mul_i32 s38, s31, 196608
    s_add_u32 s38, s38, s34
    s_add_u32 m0, s36, 49152
    s_add_u32 s32, s38, 0
    buffer_load_dwordx4 v7, s[16:19], s32 offen lds
    s_add_u32 m0, s36, 53248
    s_add_u32 s32, s38, 98304
    buffer_load_dwordx4 v7, s[16:19], s32 offen lds
    s_add_u32 m0, s36, 57344
    s_add_u32 s32, s38, 1024
    buffer_load_dwordx4 v7, s[16:19], s32 offen lds
    s_add_u32 m0, s36, 61440
    s_add_u32 s32, s38, 99328
    buffer_load_dwordx4 v7, s[16:19], s32 offen lds
    s_add_u32 m0, s36, 65536
    s_add_u32 s32, s38, 2048
    buffer_load_dwordx4 v7, s[16:19], s32 offen lds
    s_add_u32 m0, s36, 69632
    s_add_u32 s32, s38, 100352
    buffer_load_dwordx4 v7, s[16:19], s32 offen lds
    s_waitcnt vmcnt(16)
    s_barrier
    s_add_u32 s31, s30, 7
    s_and_b32 s31, s31, 7
    s_lshl_b32 s37, s31, 7
    s_add_u32 s37, s37, s33
    s_add_u32 m0, s35, 24576
    s_add_u32 s32, s37, 0
    buffer_load_dwordx4 v8, s[12:15], s32 offen lds
    s_add_u32 m0, s35, 28672
    s_add_u32 s32, s37, 32768
    buffer_load_dwordx4 v8, s[12:15], s32 offen lds
    s_add_u32 s31, s30, 7
    s_and_b32 s31, s31, 7
    s_mul_i32 s38, s31, 196608
    s_add_u32 s38, s38, s34
    s_add_u32 m0, s36, 73728
    s_add_u32 s32, s38, 0
    buffer_load_dwordx4 v7, s[16:19], s32 offen lds
    s_add_u32 m0, s36, 77824
    s_add_u32 s32, s38, 98304
    buffer_load_dwordx4 v7, s[16:19], s32 offen lds
    s_add_u32 m0, s36, 81920
    s_add_u32 s32, s38, 1024
    buffer_load_dwordx4 v7, s[16:19], s32 offen lds
    s_add_u32 m0, s36, 86016
    s_add_u32 s32, s38, 99328
    buffer_load_dwordx4 v7, s[16:19], s32 offen lds
    s_add_u32 m0, s36, 90112
    s_add_u32 s32, s38, 2048
    buffer_load_dwordx4 v7, s[16:19], s32 offen lds
    s_add_u32 m0, s36, 94208
    s_add_u32 s32, s38, 100352
    buffer_load_dwordx4 v7, s[16:19], s32 offen lds
    s_waitcnt vmcnt(16)
    s_barrier
    s_waitcnt vmcnt(8)
    s_barrier
    s_waitcnt vmcnt(0)
    s_barrier
    s_endpgm
K1_STATS:
    v_lshrrev_b32 v5, 5, v1
    v_and_b32 v6, 31, v1
    v_lshrrev_b32 v4, 1, v6
    v_and_b32 v4, 7, v4
    s_lshl_b32 s32, s39, 12
    s_lshl_b32 s31, s40, 1
    s_add_u32 s31, s31, 0
    v_add_u32 v2, s31, v5
    v_xor_b32 v2, v2, v4
    v_lshlrev_b32 v2, 4, v2
    v_lshl_add_u32 v2, v6, 7, v2
    v_add_u32 v7, s32, v2
    s_lshl_b32 s31, s40, 1
    s_add_u32 s31, s31, 4
    v_add_u32 v2, s31, v5
    v_xor_b32 v2, v2, v4
    v_lshlrev_b32 v2, 4, v2
    v_lshl_add_u32 v2, v6, 7, v2
    v_add_u32 v8, s32, v2
    v_mov_b32 v44, 0xffff0000
    v_mov_b32 v28, 0
    v_mov_b32 v36, 0
    v_mov_b32 v29, 0
    v_mov_b32 v37, 0
    v_mov_b32 v30, 0
    v_mov_b32 v38, 0
    v_mov_b32 v31, 0
    v_mov_b32 v39, 0
    v_mov_b32 v32, 0
    v_mov_b32 v40, 0
    v_mov_b32 v33, 0
    v_mov_b32 v41, 0
    v_mov_b32 v34, 0
    v_mov_b32 v42, 0
    v_mov_b32 v35, 0
    v_mov_b32 v43, 0
    s_cmp_lg_u32 s24, 9
    s_cbranch_scc1 K1_NOCPF
    s_cmp_ge_u32 s2, 32
    s_cbranch_scc1 K1_NOCPF
    s_getpc_b64 s[52:53]
K1_PCREF:
    s_sub_u32 s52, s52, K1_PCREF-k1_qkv_kernel
    s_subb_u32 s53, s53, 0
    v_lshlrev_b32 v96, 4, v1
    global_load_dwordx4 v[48:51], v96, s[52:53] offset:0
    global_load_dwordx4 v[52:55], v96, s[52:53] offset:1024
    global_load_dwordx4 v[56:59], v96, s[52:53] offset:2048
    global_load_dwordx4 v[60:63], v96, s[52:53] offset:3072
    v_add_u32 v96, 4096, v96
    global_load_dwordx4 v[64:67], v96, s[52:53] offset:0
    global_load_dwordx4 v[68:71], v96, s[52:53] offset:1024
    global_load_dwordx4 v[72:75], v96, s[52:53] offset:2048
    global_load_dwordx4 v[76:79], v96, s[52:53] offset:3072
    v_add_u32 v96, 4096, v96
    global_load_dwordx4 v[48:51], v96, s[52:53] offset:0
    global_load_dwordx4 v[52:55], v96, s[52:53] offset:1024
    global_load_dwordx4 v[56:59], v96, s[52:53] offset:2048
    global_load_dwordx4 v[60:63], v96, s[52:53] offset:3072
    v_add_u32 v96, 4096, v96
    global_load_dwordx4 v[64:67], v96, s[52:53] offset:0
    global_load_dwordx4 v[68:71], v96, s[52:53] offset:1024
    global_load_dwordx4 v[72:75], v96, s[52:53] offset:2048
    global_load_dwordx4 v[76:79], v96, s[52:53] offset:3072
    v_add_u32 v96, 4096, v96
    global_load_dwordx4 v[48:51], v96, s[52:53] offset:0
    global_load_dwordx4 v[52:55], v96, s[52:53] offset:1024
    global_load_dwordx4 v[56:59], v96, s[52:53] offset:2048
    global_load_dwordx4 v[60:63], v96, s[52:53] offset:3072
    v_add_u32 v96, 4096, v96
    global_load_dwordx4 v[64:67], v96, s[52:53] offset:0
    global_load_dwordx4 v[68:71], v96, s[52:53] offset:1024
    global_load_dwordx4 v[72:75], v96, s[52:53] offset:2048
    global_load_dwordx4 v[76:79], v96, s[52:53] offset:3072
    v_add_u32 v96, 4096, v96
    global_load_dwordx4 v[48:51], v96, s[52:53] offset:0
    global_load_dwordx4 v[52:55], v96, s[52:53] offset:1024
K1_NOCPF:
    s_mov_b32 s54, 0
    s_cmp_lg_u32 s24, 8
    s_cbranch_scc1 K1_NOCS0
    s_waitcnt lgkmcnt(0)
    s_cmp_ge_u32 s2, 48
    s_cbranch_scc1 K1_NOZ
    s_mov_b32 s44, s8
    s_and_b32 s45, s9, 0xffff
    s_mov_b32 s46, 25165824
    s_mov_b32 s47, 0x20000
    s_lshl_b32 s48, s2, 8
    s_add_u32 s48, s48, 22020096
    v_mov_b32 v2, 0
    v_lshlrev_b32 v3, 2, v1
    s_mov_b32 exec_hi, 0
    buffer_store_dword v2, v3, s[44:47], s48 offen
    s_mov_b64 exec, -1
K1_NOZ:
    s_cmp_ge_u32 s2, 224
    s_cbranch_scc1 K1_NOCS0
    s_mov_b32 s54, 1
    s_load_dwordx2 s[52:53], s[0:1], 32
    s_mul_i32 s48, s2, 2341
    s_lshr_b32 s48, s48, 16
    s_mul_i32 s49, s48, 28
    s_sub_u32 s49, s2, s49
    v_lshrrev_b32 v96, 3, v1
    v_mul_u32_u24 v96, 3584, v96
    v_and_b32 v2, 7, v1
    v_lshl_add_u32 v96, v2, 4, v96
    s_mul_i32 s50, s48, 229376
    s_lshl_b32 s51, s49, 7
    s_add_u32 s50, s50, s51
    s_waitcnt lgkmcnt(0)
    s_mov_b32 s44, s52
    s_and_b32 s45, s53, 0xffff
    s_mov_b32 s46, 1835008
    s_mov_b32 s47, 0x20000
    buffer_load_dwordx4 v[48:51], v96, s[44:47], s50 offen
    s_add_u32 s50, s50, 28672
    buffer_load_dwordx4 v[52:55], v96, s[44:47], s50 offen
    s_add_u32 s50, s50, 28672
    buffer_load_dwordx4 v[56:59], v96, s[44:47], s50 offen
    s_add_u32 s50, s50, 28672
    buffer_load_dwordx4 v[60:63], v96, s[44:47], s50 offen
    s_add_u32 s50, s50, 28672
    buffer_load_dwordx4 v[64:67], v96, s[44:47], s50 offen
    s_add_u32 s50, s50, 28672
    buffer_load_dwordx4 v[68:71], v96, s[44:47], s50 offen
    s_add_u32 s50, s50, 28672
    buffer_load_dwordx4 v[72:75], v96, s[44:47], s50 offen
    s_add_u32 s50, s50, 28672
    buffer_load_dwordx4 v[76:79], v96, s[44:47], s50 offen
    s_add_u32 s50, s50, 28672
K1_NOCS0:
    v_mov_b32 v80, 0
    v_mov_b32 v81, 0
    v_mov_b32 v82, 0
    v_mov_b32 v83, 0
    v_mov_b32 v84, 0
    v_mov_b32 v85, 0
    v_mov_b32 v86, 0
    v_mov_b32 v87, 0
    s_barrier
    ds_read_b128 v[12:15], v7 offset:0
    ds_read_b128 v[16:19], v8 offset:0
    s_waitcnt lgkmcnt(1)
    v_lshlrev_b32 v20, 16, v12
    v_and_b32 v21, v44, v12
    v_lshlrev_b32 v22, 16, v13
    v_and_b32 v23, v44, v13
    v_lshlrev_b32 v24, 16, v14
    v_and_b32 v25, v44, v14
    v_lshlrev_b32 v26, 16, v15
    v_and_b32 v27, v44, v15
    v_fmac_f32 v28, v20, v20
    v_add_f32 v36, v20, v36
    v_fmac_f32 v29, v21, v21
    v_add_f32 v37, v21, v37
    v_fmac_f32 v30, v22, v22
    v_add_f32 v38, v22, v38
    v_fmac_f32 v31, v23, v23
    v_add_f32 v39, v23, v39
    v_fmac_f32 v32, v24, v24
    v_add_f32 v40, v24, v40
    v_fmac_f32 v33, v25, v25
    v_add_f32 v41, v25, v41
    v_fmac_f32 v34, v26, v26
    v_add_f32 v42, v26, v42
    v_fmac_f32 v35, v27, v27
    v_add_f32 v43, v27, v43
    s_waitcnt lgkmcnt(0)
    v_lshlrev_b32 v20, 16, v16
    v_and_b32 v21, v44, v16
    v_lshlrev_b32 v22, 16, v17
    v_and_b32 v23, v44, v17
    v_lshlrev_b32 v24, 16, v18
    v_and_b32 v25, v44, v18
    v_lshlrev_b32 v26, 16, v19
    v_and_b32 v27, v44, v19
    v_fmac_f32 v28, v20, v20
    v_add_f32 v36, v20, v36
    v_fmac_f32 v29, v21, v21
    v_add_f32 v37, v21, v37
    v_fmac_f32 v30, v22, v22
    v_add_f32 v38, v22, v38
    v_fmac_f32 v31, v23, v23
    v_add_f32 v39, v23, v39
    v_fmac_f32 v32, v24, v24
    v_add_f32 v40, v24, v40
    v_fmac_f32 v33, v25, v25
    v_add_f32 v41, v25, v41
    v_fmac_f32 v34, v26, v26
    v_add_f32 v42, v26, v42
    v_fmac_f32 v35, v27, v27
    v_add_f32 v43, v27, v43
    s_barrier
    ds_read_b128 v[12:15], v7 offset:8192
    ds_read_b128 v[16:19], v8 offset:8192
    s_waitcnt lgkmcnt(1)
    v_lshlrev_b32 v20, 16, v12
    v_and_b32 v21, v44, v12
    v_lshlrev_b32 v22, 16, v13
    v_and_b32 v23, v44, v13
    v_lshlrev_b32 v24, 16, v14
    v_and_b32 v25, v44, v14
    v_lshlrev_b32 v26, 16, v15
    v_and_b32 v27, v44, v15
    v_fmac_f32 v28, v20, v20
    v_add_f32 v36, v20, v36
    v_fmac_f32 v29, v21, v21
    v_add_f32 v37, v21, v37
    v_fmac_f32 v30, v22, v22
    v_add_f32 v38, v22, v38
    v_fmac_f32 v31, v23, v23
    v_add_f32 v39, v23, v39
    v_fmac_f32 v32, v24, v24
    v_add_f32 v40, v24, v40
    v_fmac_f32 v33, v25, v25
    v_add_f32 v41, v25, v41
    v_fmac_f32 v34, v26, v26
    v_add_f32 v42, v26, v42
    v_fmac_f32 v35, v27, v27
    v_add_f32 v43, v27, v43
    s_waitcnt lgkmcnt(0)
    v_lshlrev_b32 v20, 16, v16
    v_and_b32 v21, v44, v16
    v_lshlrev_b32 v22, 16, v17
    v_and_b32 v23, v44, v17
    v_lshlrev_b32 v24, 16, v18
    v_and_b32 v25, v44, v18
    v_lshlrev_b32 v26, 16, v19
    v_and_b32 v27, v44, v19
    v_fmac_f32 v28, v20, v20
    v_add_f32 v36, v20, v36
    v_fmac_f32 v29, v21, v21
    v_add_f32 v37, v21, v37
    v_fmac_f32 v30, v22, v22
    v_add_f32 v38, v22, v38
    v_fmac_f32 v31, v23, v23
    v_add_f32 v39, v23, v39
    v_fmac_f32 v32, v24, v24
    v_add_f32 v40, v24, v40
    v_fmac_f32 v33, v25, v25
    v_add_f32 v41, v25, v41
    v_fmac_f32 v34, v26, v26
    v_add_f32 v42, v26, v42
    v_fmac_f32 v35, v27, v27
    v_add_f32 v43, v27, v43
    s_barrier
    ds_read_b128 v[12:15], v7 offset:16384
    ds_read_b128 v[16:19], v8 offset:16384
    s_waitcnt lgkmcnt(1)
    v_lshlrev_b32 v20, 16, v12
    v_and_b32 v21, v44, v12
    v_lshlrev_b32 v22, 16, v13
    v_and_b32 v23, v44, v13
    v_lshlrev_b32 v24, 16, v14
    v_and_b32 v25, v44, v14
    v_lshlrev_b32 v26, 16, v15
    v_and_b32 v27, v44, v15
    v_fmac_f32 v28, v20, v20
    v_add_f32 v36, v20, v36
    v_fmac_f32 v29, v21, v21
    v_add_f32 v37, v21, v37
    v_fmac_f32 v30, v22, v22
    v_add_f32 v38, v22, v38
    v_fmac_f32 v31, v23, v23
    v_add_f32 v39, v23, v39
    v_fmac_f32 v32, v24, v24
    v_add_f32 v40, v24, v40
    v_fmac_f32 v33, v25, v25
    v_add_f32 v41, v25, v41
    v_fmac_f32 v34, v26, v26
    v_add_f32 v42, v26, v42
    v_fmac_f32 v35, v27, v27
    v_add_f32 v43, v27, v43
    s_waitcnt lgkmcnt(0)
    v_lshlrev_b32 v20, 16, v16
    v_and_b32 v21, v44, v16
    v_lshlrev_b32 v22, 16, v17
    v_and_b32 v23, v44, v17
    v_lshlrev_b32 v24, 16, v18
    v_and_b32 v25, v44, v18
    v_lshlrev_b32 v26, 16, v19
    v_and_b32 v27, v44, v19
    v_fmac_f32 v28, v20, v20
    v_add_f32 v36, v20, v36
    v_fmac_f32 v29, v21, v21
    v_add_f32 v37, v21, v37
    v_fmac_f32 v30, v22, v22
    v_add_f32 v38, v22, v38
    v_fmac_f32 v31, v23, v23
    v_add_f32 v39, v23, v39
    v_fmac_f32 v32, v24, v24
    v_add_f32 v40, v24, v40
    v_fmac_f32 v33, v25, v25
    v_add_f32 v41, v25, v41
    v_fmac_f32 v34, v26, v26
    v_add_f32 v42, v26, v42
    v_fmac_f32 v35, v27, v27
    v_add_f32 v43, v27, v43
    s_barrier
    ds_read_b128 v[12:15], v7 offset:24576
    ds_read_b128 v[16:19], v8 offset:24576
    s_waitcnt lgkmcnt(1)
    v_lshlrev_b32 v20, 16, v12
    v_and_b32 v21, v44, v12
    v_lshlrev_b32 v22, 16, v13
    v_and_b32 v23, v44, v13
    v_lshlrev_b32 v24, 16, v14
    v_and_b32 v25, v44, v14
    v_lshlrev_b32 v26, 16, v15
    v_and_b32 v27, v44, v15
    v_fmac_f32 v28, v20, v20
    v_add_f32 v36, v20, v36
    v_fmac_f32 v29, v21, v21
    v_add_f32 v37, v21, v37
    v_fmac_f32 v30, v22, v22
    v_add_f32 v38, v22, v38
    v_fmac_f32 v31, v23, v23
    v_add_f32 v39, v23, v39
    v_fmac_f32 v32, v24, v24
    v_add_f32 v40, v24, v40
    v_fmac_f32 v33, v25, v25
    v_add_f32 v41, v25, v41
    v_fmac_f32 v34, v26, v26
    v_add_f32 v42, v26, v42
    v_fmac_f32 v35, v27, v27
    v_add_f32 v43, v27, v43
    s_waitcnt lgkmcnt(0)
    v_lshlrev_b32 v20, 16, v16
    v_and_b32 v21, v44, v16
    v_lshlrev_b32 v22, 16, v17
    v_and_b32 v23, v44, v17
    v_lshlrev_b32 v24, 16, v18
    v_and_b32 v25, v44, v18
    v_lshlrev_b32 v26, 16, v19
    v_and_b32 v27, v44, v19
    v_fmac_f32 v28, v20, v20
    v_add_f32 v36, v20, v36
    v_fmac_f32 v29, v21, v21
    v_add_f32 v37, v21, v37
    v_fmac_f32 v30, v22, v22
    v_add_f32 v38, v22, v38
    v_fmac_f32 v31, v23, v23
    v_add_f32 v39, v23, v39
    v_fmac_f32 v32, v24, v24
    v_add_f32 v40, v24, v40
    v_fmac_f32 v33, v25, v25
    v_add_f32 v41, v25, v41
    v_fmac_f32 v34, v26, v26
    v_add_f32 v42, v26, v42
    v_fmac_f32 v35, v27, v27
    v_add_f32 v43, v27, v43
    s_barrier
    ds_read_b128 v[12:15], v7 offset:0
    ds_read_b128 v[16:19], v8 offset:0
    s_waitcnt lgkmcnt(1)
    v_lshlrev_b32 v20, 16, v12
    v_and_b32 v21, v44, v12
    v_lshlrev_b32 v22, 16, v13
    v_and_b32 v23, v44, v13
    v_lshlrev_b32 v24, 16, v14
    v_and_b32 v25, v44, v14
    v_lshlrev_b32 v26, 16, v15
    v_and_b32 v27, v44, v15
    v_fmac_f32 v28, v20, v20
    v_add_f32 v36, v20, v36
    v_fmac_f32 v29, v21, v21
    v_add_f32 v37, v21, v37
    v_fmac_f32 v30, v22, v22
    v_add_f32 v38, v22, v38
    v_fmac_f32 v31, v23, v23
    v_add_f32 v39, v23, v39
    v_fmac_f32 v32, v24, v24
    v_add_f32 v40, v24, v40
    v_fmac_f32 v33, v25, v25
    v_add_f32 v41, v25, v41
    v_fmac_f32 v34, v26, v26
    v_add_f32 v42, v26, v42
    v_fmac_f32 v35, v27, v27
    v_add_f32 v43, v27, v43
    s_waitcnt lgkmcnt(0)
    v_lshlrev_b32 v20, 16, v16
    v_and_b32 v21, v44, v16
    v_lshlrev_b32 v22, 16, v17
    v_and_b32 v23, v44, v17
    v_lshlrev_b32 v24, 16, v18
    v_and_b32 v25, v44, v18
    v_lshlrev_b32 v26, 16, v19
    v_and_b32 v27, v44, v19
    v_fmac_f32 v28, v20, v20
    v_add_f32 v36, v20, v36
    v_fmac_f32 v29, v21, v21
    v_add_f32 v37, v21, v37
    v_fmac_f32 v30, v22, v22
    v_add_f32 v38, v22, v38
    v_fmac_f32 v31, v23, v23
    v_add_f32 v39, v23, v39
    v_fmac_f32 v32, v24, v24
    v_add_f32 v40, v24, v40
    v_fmac_f32 v33, v25, v25
    v_add_f32 v41, v25, v41
    v_fmac_f32 v34, v26, v26
    v_add_f32 v42, v26, v42
    v_fmac_f32 v35, v27, v27
    v_add_f32 v43, v27, v43
    s_barrier
    ds_read_b128 v[12:15], v7 offset:8192
    ds_read_b128 v[16:19], v8 offset:8192
    s_waitcnt lgkmcnt(1)
    v_lshlrev_b32 v20, 16, v12
    v_and_b32 v21, v44, v12
    v_lshlrev_b32 v22, 16, v13
    v_and_b32 v23, v44, v13
    v_lshlrev_b32 v24, 16, v14
    v_and_b32 v25, v44, v14
    v_lshlrev_b32 v26, 16, v15
    v_and_b32 v27, v44, v15
    v_fmac_f32 v28, v20, v20
    v_add_f32 v36, v20, v36
    v_fmac_f32 v29, v21, v21
    v_add_f32 v37, v21, v37
    v_fmac_f32 v30, v22, v22
    v_add_f32 v38, v22, v38
    v_fmac_f32 v31, v23, v23
    v_add_f32 v39, v23, v39
    v_fmac_f32 v32, v24, v24
    v_add_f32 v40, v24, v40
    v_fmac_f32 v33, v25, v25
    v_add_f32 v41, v25, v41
    v_fmac_f32 v34, v26, v26
    v_add_f32 v42, v26, v42
    v_fmac_f32 v35, v27, v27
    v_add_f32 v43, v27, v43
    s_waitcnt lgkmcnt(0)
    v_lshlrev_b32 v20, 16, v16
    v_and_b32 v21, v44, v16
    v_lshlrev_b32 v22, 16, v17
    v_and_b32 v23, v44, v17
    v_lshlrev_b32 v24, 16, v18
    v_and_b32 v25, v44, v18
    v_lshlrev_b32 v26, 16, v19
    v_and_b32 v27, v44, v19
    v_fmac_f32 v28, v20, v20
    v_add_f32 v36, v20, v36
    v_fmac_f32 v29, v21, v21
    v_add_f32 v37, v21, v37
    v_fmac_f32 v30, v22, v22
    v_add_f32 v38, v22, v38
    v_fmac_f32 v31, v23, v23
    v_add_f32 v39, v23, v39
    v_fmac_f32 v32, v24, v24
    v_add_f32 v40, v24, v40
    v_fmac_f32 v33, v25, v25
    v_add_f32 v41, v25, v41
    v_fmac_f32 v34, v26, v26
    v_add_f32 v42, v26, v42
    v_fmac_f32 v35, v27, v27
    v_add_f32 v43, v27, v43
    s_barrier
    ds_read_b128 v[12:15], v7 offset:16384
    ds_read_b128 v[16:19], v8 offset:16384
    s_waitcnt lgkmcnt(1)
    v_lshlrev_b32 v20, 16, v12
    v_and_b32 v21, v44, v12
    v_lshlrev_b32 v22, 16, v13
    v_and_b32 v23, v44, v13
    v_lshlrev_b32 v24, 16, v14
    v_and_b32 v25, v44, v14
    v_lshlrev_b32 v26, 16, v15
    v_and_b32 v27, v44, v15
    v_fmac_f32 v28, v20, v20
    v_add_f32 v36, v20, v36
    v_fmac_f32 v29, v21, v21
    v_add_f32 v37, v21, v37
    v_fmac_f32 v30, v22, v22
    v_add_f32 v38, v22, v38
    v_fmac_f32 v31, v23, v23
    v_add_f32 v39, v23, v39
    v_fmac_f32 v32, v24, v24
    v_add_f32 v40, v24, v40
    v_fmac_f32 v33, v25, v25
    v_add_f32 v41, v25, v41
    v_fmac_f32 v34, v26, v26
    v_add_f32 v42, v26, v42
    v_fmac_f32 v35, v27, v27
    v_add_f32 v43, v27, v43
    s_waitcnt lgkmcnt(0)
    v_lshlrev_b32 v20, 16, v16
    v_and_b32 v21, v44, v16
    v_lshlrev_b32 v22, 16, v17
    v_and_b32 v23, v44, v17
    v_lshlrev_b32 v24, 16, v18
    v_and_b32 v25, v44, v18
    v_lshlrev_b32 v26, 16, v19
    v_and_b32 v27, v44, v19
    v_fmac_f32 v28, v20, v20
    v_add_f32 v36, v20, v36
    v_fmac_f32 v29, v21, v21
    v_add_f32 v37, v21, v37
    v_fmac_f32 v30, v22, v22
    v_add_f32 v38, v22, v38
    v_fmac_f32 v31, v23, v23
    v_add_f32 v39, v23, v39
    v_fmac_f32 v32, v24, v24
    v_add_f32 v40, v24, v40
    v_fmac_f32 v33, v25, v25
    v_add_f32 v41, v25, v41
    v_fmac_f32 v34, v26, v26
    v_add_f32 v42, v26, v42
    v_fmac_f32 v35, v27, v27
    v_add_f32 v43, v27, v43
    s_barrier
    ds_read_b128 v[12:15], v7 offset:24576
    ds_read_b128 v[16:19], v8 offset:24576
    s_waitcnt lgkmcnt(1)
    v_lshlrev_b32 v20, 16, v12
    v_and_b32 v21, v44, v12
    v_lshlrev_b32 v22, 16, v13
    v_and_b32 v23, v44, v13
    v_lshlrev_b32 v24, 16, v14
    v_and_b32 v25, v44, v14
    v_lshlrev_b32 v26, 16, v15
    v_and_b32 v27, v44, v15
    v_fmac_f32 v28, v20, v20
    v_add_f32 v36, v20, v36
    v_fmac_f32 v29, v21, v21
    v_add_f32 v37, v21, v37
    v_fmac_f32 v30, v22, v22
    v_add_f32 v38, v22, v38
    v_fmac_f32 v31, v23, v23
    v_add_f32 v39, v23, v39
    v_fmac_f32 v32, v24, v24
    v_add_f32 v40, v24, v40
    v_fmac_f32 v33, v25, v25
    v_add_f32 v41, v25, v41
    v_fmac_f32 v34, v26, v26
    v_add_f32 v42, v26, v42
    v_fmac_f32 v35, v27, v27
    v_add_f32 v43, v27, v43
    s_waitcnt lgkmcnt(0)
    v_lshlrev_b32 v20, 16, v16
    v_and_b32 v21, v44, v16
    v_lshlrev_b32 v22, 16, v17
    v_and_b32 v23, v44, v17
    v_lshlrev_b32 v24, 16, v18
    v_and_b32 v25, v44, v18
    v_lshlrev_b32 v26, 16, v19
    v_and_b32 v27, v44, v19
    v_fmac_f32 v28, v20, v20
    v_add_f32 v36, v20, v36
    v_fmac_f32 v29, v21, v21
    v_add_f32 v37, v21, v37
    v_fmac_f32 v30, v22, v22
    v_add_f32 v38, v22, v38
    v_fmac_f32 v31, v23, v23
    v_add_f32 v39, v23, v39
    v_fmac_f32 v32, v24, v24
    v_add_f32 v40, v24, v40
    v_fmac_f32 v33, v25, v25
    v_add_f32 v41, v25, v41
    v_fmac_f32 v34, v26, v26
    v_add_f32 v42, v26, v42
    v_fmac_f32 v35, v27, v27
    v_add_f32 v43, v27, v43
    v_add_f32 v28, v28, v32
    v_add_f32 v29, v29, v33
    v_add_f32 v30, v30, v34
    v_add_f32 v31, v31, v35
    v_add_f32 v28, v28, v30
    v_add_f32 v29, v29, v31
    v_add_f32 v28, v28, v29
    v_add_f32 v36, v36, v40
    v_add_f32 v37, v37, v41
    v_add_f32 v38, v38, v42
    v_add_f32 v39, v39, v43
    v_add_f32 v36, v36, v38
    v_add_f32 v37, v37, v39
    v_add_f32 v36, v36, v37
    v_mov_b32 v3, v36
    s_nop 1
    v_permlane32_swap_b32 v36, v3
    v_add_f32 v36, v36, v3
    v_mov_b32 v4, v28
    s_nop 1
    v_permlane32_swap_b32 v28, v4
    v_add_f32 v28, v28, v4
    s_lshl_b32 s31, s25, 8
    s_add_u32 s31, s31, 132608
    v_lshl_add_u32 v2, v6, 2, s31
    ds_write_b32 v2, v36
    ds_write_b32 v2, v28 offset:128
    s_waitcnt lgkmcnt(0)
    s_barrier
    s_cmp_eq_u32 s54, 0
    s_cbranch_scc1 K1_NOCS1
    s_waitcnt vmcnt(0)
    v_lshlrev_b32 v88, 16, v48
    v_and_b32 v89, 0xffff0000, v48
    v_lshlrev_b32 v90, 16, v49
    v_and_b32 v91, 0xffff0000, v49
    v_lshlrev_b32 v92, 16, v50
    v_and_b32 v93, 0xffff0000, v50
    v_lshlrev_b32 v94, 16, v51
    v_and_b32 v95, 0xffff0000, v51
    v_add_f32 v80, v80, v88
    v_add_f32 v81, v81, v89
    v_add_f32 v82, v82, v90
    v_add_f32 v83, v83, v91
    v_add_f32 v84, v84, v92
    v_add_f32 v85, v85, v93
    v_add_f32 v86, v86, v94
    v_add_f32 v87, v87, v95
    v_lshlrev_b32 v88, 16, v52
    v_and_b32 v89, 0xffff0000, v52
    v_lshlrev_b32 v90, 16, v53
    v_and_b32 v91, 0xffff0000, v53
    v_lshlrev_b32 v92, 16, v54
    v_and_b32 v93, 0xffff0000, v54
    v_lshlrev_b32 v94, 16, v55
    v_and_b32 v95, 0xffff0000, v55
    v_add_f32 v80, v80, v88
    v_add_f32 v81, v81, v89
    v_add_f32 v82, v82, v90
    v_add_f32 v83, v83, v91
    v_add_f32 v84, v84, v92
    v_add_f32 v85, v85, v93
    v_add_f32 v86, v86, v94
    v_add_f32 v87, v87, v95
    v_lshlrev_b32 v88, 16, v56
    v_and_b32 v89, 0xffff0000, v56
    v_lshlrev_b32 v90, 16, v57
    v_and_b32 v91, 0xffff0000, v57
    v_lshlrev_b32 v92, 16, v58
    v_and_b32 v93, 0xffff0000, v58
    v_lshlrev_b32 v94, 16, v59
    v_and_b32 v95, 0xffff0000, v59
    v_add_f32 v80, v80, v88
    v_add_f32 v81, v81, v89
    v_add_f32 v82, v82, v90
    v_add_f32 v83, v83, v91
    v_add_f32 v84, v84, v92
    v_add_f32 v85, v85, v93
    v_add_f32 v86, v86, v94
    v_add_f32 v87, v87, v95
    v_lshlrev_b32 v88, 16, v60
    v_and_b32 v89, 0xffff0000, v60
    v_lshlrev_b32 v90, 16, v61
    v_and_b32 v91, 0xffff0000, v61
    v_lshlrev_b32 v92, 16, v62
    v_and_b32 v93, 0xffff0000, v62
    v_lshlrev_b32 v94, 16, v63
    v_and_b32 v95, 0xffff0000, v63
    v_add_f32 v80, v80, v88
    v_add_f32 v81, v81, v89
    v_add_f32 v82, v82, v90
    v_add_f32 v83, v83, v91
    v_add_f32 v84, v84, v92
    v_add_f32 v85, v85, v93
    v_add_f32 v86, v86, v94
    v_add_f32 v87, v87, v95
    v_lshlrev_b32 v88, 16, v64
    v_and_b32 v89, 0xffff0000, v64
    v_lshlrev_b32 v90, 16, v65
    v_and_b32 v91, 0xffff0000, v65
    v_lshlrev_b32 v92, 16, v66
    v_and_b32 v93, 0xffff0000, v66
    v_lshlrev_b32 v94, 16, v67
    v_and_b32 v95, 0xffff0000, v67
    v_add_f32 v80, v80, v88
    v_add_f32 v81, v81, v89
    v_add_f32 v82, v82, v90
    v_add_f32 v83, v83, v91
    v_add_f32 v84, v84, v92
    v_add_f32 v85, v85, v93
    v_add_f32 v86, v86, v94
    v_add_f32 v87, v87, v95
    v_lshlrev_b32 v88, 16, v68
    v_and_b32 v89, 0xffff0000, v68
    v_lshlrev_b32 v90, 16, v69
    v_and_b32 v91, 0xffff0000, v69
    v_lshlrev_b32 v92, 16, v70
    v_and_b32 v93, 0xffff0000, v70
    v_lshlrev_b32 v94, 16, v71
    v_and_b32 v95, 0xffff0000, v71
    v_add_f32 v80, v80, v88
    v_add_f32 v81, v81, v89
    v_add_f32 v82, v82, v90
    v_add_f32 v83, v83, v91
    v_add_f32 v84, v84, v92
    v_add_f32 v85, v85, v93
    v_add_f32 v86, v86, v94
    v_add_f32 v87, v87, v95
    v_lshlrev_b32 v88, 16, v72
    v_and_b32 v89, 0xffff0000, v72
    v_lshlrev_b32 v90, 16, v73
    v_and_b32 v91, 0xffff0000, v73
    v_lshlrev_b32 v92, 16, v74
    v_and_b32 v93, 0xffff0000, v74
    v_lshlrev_b32 v94, 16, v75
    v_and_b32 v95, 0xffff0000, v75
    v_add_f32 v80, v80, v88
    v_add_f32 v81, v81, v89
    v_add_f32 v82, v82, v90
    v_add_f32 v83, v83, v91
    v_add_f32 v84, v84, v92
    v_add_f32 v85, v85, v93
    v_add_f32 v86, v86, v94
    v_add_f32 v87, v87, v95
    v_lshlrev_b32 v88, 16, v76
    v_and_b32 v89, 0xffff0000, v76
    v_lshlrev_b32 v90, 16, v77
    v_and_b32 v91, 0xffff0000, v77
    v_lshlrev_b32 v92, 16, v78
    v_and_b32 v93, 0xffff0000, v78
    v_lshlrev_b32 v94, 16, v79
    v_and_b32 v95, 0xffff0000, v79
    v_add_f32 v80, v80, v88
    v_add_f32 v81, v81, v89
    v_add_f32 v82, v82, v90
    v_add_f32 v83, v83, v91
    v_add_f32 v84, v84, v92
    v_add_f32 v85, v85, v93
    v_add_f32 v86, v86, v94
    v_add_f32 v87, v87, v95
    v_add_f32_dpp v80, v80, v80 row_ror:8 row_mask:0xf bank_mask:0xf
    v_add_f32_dpp v81, v81, v81 row_ror:8 row_mask:0xf bank_mask:0xf
    v_add_f32_dpp v82, v82, v82 row_ror:8 row_mask:0xf bank_mask:0xf
    v_add_f32_dpp v83, v83, v83 row_ror:8 row_mask:0xf bank_mask:0xf
    v_add_f32_dpp v84, v84, v84 row_ror:8 row_mask:0xf bank_mask:0xf
    v_add_f32_dpp v85, v85, v85 row_ror:8 row_mask:0xf bank_mask:0xf
    v_add_f32_dpp v86, v86, v86 row_ror:8 row_mask:0xf bank_mask:0xf
    v_add_f32_dpp v87, v87, v87 row_ror:8 row_mask:0xf bank_mask:0xf
    v_mov_b32 v88, v80
    v_mov_b32 v89, v81
    v_mov_b32 v90, v82
    v_mov_b32 v91, v83
    v_mov_b32 v92, v84
    v_mov_b32 v93, v85
    v_mov_b32 v94, v86
    v_mov_b32 v95, v87
    v_permlane16_swap_b32 v80, v88
    v_permlane16_swap_b32 v81, v89
    v_permlane16_swap_b32 v82, v90
    v_permlane16_swap_b32 v83, v91
    v_permlane16_swap_b32 v84, v92
    v_permlane16_swap_b32 v85, v93
    v_permlane16_swap_b32 v86, v94
    v_permlane16_swap_b32 v87, v95
    v_add_f32 v80, v80, v88
    v_add_f32 v81, v81, v89
    v_add_f32 v82, v82, v90
    v_add_f32 v83, v83, v91
    v_add_f32 v84, v84, v92
    v_add_f32 v85, v85, v93
    v_add_f32 v86, v86, v94
    v_add_f32 v87, v87, v95
    v_mov_b32 v88, v80
    v_mov_b32 v89, v81
    v_mov_b32 v90, v82
    v_mov_b32 v91, v83
    v_mov_b32 v92, v84
    v_mov_b32 v93, v85
    v_mov_b32 v94, v86
    v_mov_b32 v95, v87
    v_permlane32_swap_b32 v80, v88
    v_permlane32_swap_b32 v81, v89
    v_permlane32_swap_b32 v82, v90
    v_permlane32_swap_b32 v83, v91
    v_permlane32_swap_b32 v84, v92
    v_permlane32_swap_b32 v85, v93
    v_permlane32_swap_b32 v86, v94
    v_permlane32_swap_b32 v87, v95
    v_add_f32 v80, v80, v88
    v_add_f32 v81, v81, v89
    v_add_f32 v82, v82, v90
    v_add_f32 v83, v83, v91
    v_add_f32 v84, v84, v92
    v_add_f32 v85, v85, v93
    v_add_f32 v86, v86, v94
    v_add_f32 v87, v87, v95
    s_mov_b32 s44, s8
    s_and_b32 s45, s9, 0xffff
    s_mov_b32 s46, 25165824
    s_mov_b32 s47, 0x20000
    s_mul_i32 s50, s48, 7168
    s_lshl_b32 s51, s49, 8
    s_add_u32 s50, s50, s51
    s_add_u32 s50, s50, 21495808
    v_and_b32 v2, 7, v1
    v_lshlrev_b32 v2, 5, v2
    s_mov_b64 exec, 0xff
    buffer_store_dwordx4 v[80:83], v2, s[44:47], s50 offen
    buffer_store_dwordx4 v[84:87], v2, s[44:47], s50 offen offset:16
K1_NOCS1:
    s_endpgm
K1_COMPUTE:
    v_lshrrev_b32 v5, 5, v1
    v_and_b32 v6, 31, v1
    v_lshrrev_b32 v4, 1, v6
    v_and_b32 v4, 7, v4
    s_lshl_b32 s32, s39, 12
    s_xor_b32 s31, s39, 0
    s_lshl_b32 s31, s31, 1
    v_add_u32 v2, s31, v5
    v_xor_b32 v2, v2, v4
    v_lshlrev_b32 v2, 4, v2
    v_lshl_add_u32 v2, v6, 7, v2
    v_add_u32 v7, s32, v2
    s_xor_b32 s31, s39, 1
    s_lshl_b32 s31, s31, 1
    v_add_u32 v2, s31, v5
    v_xor_b32 v2, v2, v4
    v_lshlrev_b32 v2, 4, v2
    v_lshl_add_u32 v2, v6, 7, v2
    v_add_u32 v8, s32, v2
    s_xor_b32 s31, s39, 2
    s_lshl_b32 s31, s31, 1
    v_add_u32 v2, s31, v5
    v_xor_b32 v2, v2, v4
    v_lshlrev_b32 v2, 4, v2
    v_lshl_add_u32 v2, v6, 7, v2
    v_add_u32 v9, s32, v2
    s_xor_b32 s31, s39, 3
    s_lshl_b32 s31, s31, 1
    v_add_u32 v2, s31, v5
    v_xor_b32 v2, v2, v4
    v_lshlrev_b32 v2, 4, v2
    v_lshl_add_u32 v2, v6, 7, v2
    v_add_u32 v10, s32, v2
    v_and_b32 v2, 15, v1
    v_lshrrev_b32 v3, 2, v2
    v_lshlrev_b32 v3, 6, v3
    v_lshl_add_u32 v3, v5, 10, v3
    v_and_b32 v2, 3, v2
    v_lshl_add_u32 v3, v2, 3, v3
    v_bfe_u32 v2, v1, 4, 1
    v_lshl_add_u32 v3, v2, 5, v3
    v_add_u32 v11, 32768, v3
    s_lshl_b32 s38, s40, 9
    s_lshl_b32 s31, s39, 11
    s_sub_u32 s32, s38, s31
    s_add_u32 s38, s38, s31
    v_add_u32 v12, s32, v11
    v_add_u32 v11, s38, v11
    v_add_u32 v13, 49152, v11
    v_add_u32 v14, 49152, v12
    v_and_b32 v2, 15, v1
    v_bfe_u32 v3, v1, 4, 1
    v_cmp_eq_u32 vcc, v2, v3
    v_mov_b32 v2, 0x3f803f80
    s_nop 0
    v_cndmask_b32 v76, 0, v2, vcc
    v_cndmask_b32 v77, 0, v2, vcc
    v_cndmask_b32 v78, 0, v2, vcc
    v_cndmask_b32 v79, 0, v2, vcc
    s_waitcnt lgkmcnt(0)
    s_mov_b32 s20, s8
    s_and_b32 s21, s9, 0xffff
    s_mov_b32 s22, 25165824
    s_mov_b32 s23, 0x20000
    s_lshl_b32 s55, s28, 1
    s_add_u32 s55, s55, s39
    s_lshl_b32 s56, s29, 1
    s_add_u32 s56, s56, s40
    s_lshl_b32 s31, s56, 17
    s_lshl_b32 s32, s55, 10
    s_add_u32 s57, s31, s32
    s_add_u32 s58, s57, 2097152
    s_add_u32 s59, s57, 4194304
    s_barrier
    ds_read_b128 v[80:83], v7 offset:0
    ds_read_b64_tr_b16 v[88:89], v11 offset:0
    ds_read_b64_tr_b16 v[90:91], v11 offset:256
    ds_read_b64_tr_b16 v[92:93], v11 offset:8192
    ds_read_b64_tr_b16 v[94:95], v11 offset:8448
    ds_read_b64_tr_b16 v[96:97], v11 offset:16384
    ds_read_b64_tr_b16 v[98:99], v11 offset:16640
    ds_read_b128 v[84:87], v8 offset:0
    ds_read_b64_tr_b16 v[100:101], v12 offset:2048
    ds_read_b64_tr_b16 v[102:103], v12 offset:2304
    ds_read_b64_tr_b16 v[104:105], v12 offset:10240
    ds_read_b64_tr_b16 v[106:107], v12 offset:10496
    ds_read_b64_tr_b16 v[108:109], v12 offset:18432
    ds_read_b64_tr_b16 v[110:111], v12 offset:18688
    s_waitcnt lgkmcnt(7)
    v_mfma_f32_32x32x16_bf16 v[16:31], v[88:91], v[80:83], 0
    v_mfma_f32_16x16x32_bf16 v[64:67], v[88:91], v[76:79], 0
    v_mfma_f32_32x32x16_bf16 v[32:47], v[92:95], v[80:83], 0
    v_mfma_f32_16x16x32_bf16 v[68:71], v[92:95], v[76:79], 0
    v_mfma_f32_32x32x16_bf16 v[48:63], v[80:83], v[96:99], 0
    v_mfma_f32_16x16x32_bf16 v[72:75], v[96:99], v[76:79], 0
    ds_read_b128 v[80:83], v9 offset:0
    ds_read_b64_tr_b16 v[88:89], v11 offset:4096
    ds_read_b64_tr_b16 v[90:91], v11 offset:4352
    ds_read_b64_tr_b16 v[92:93], v11 offset:12288
    ds_read_b64_tr_b16 v[94:95], v11 offset:12544
    ds_read_b64_tr_b16 v[96:97], v11 offset:20480
    ds_read_b64_tr_b16 v[98:99], v11 offset:20736
    s_waitcnt lgkmcnt(7)
    v_mfma_f32_32x32x16_bf16 v[16:31], v[100:103], v[84:87], v[16:31]
    v_mfma_f32_32x32x16_bf16 v[32:47], v[104:107], v[84:87], v[32:47]
    v_mfma_f32_32x32x16_bf16 v[48:63], v[84:87], v[108:111], v[48:63]
    ds_read_b128 v[84:87], v10 offset:0
    ds_read_b64_tr_b16 v[100:101], v12 offset:6144
    ds_read_b64_tr_b16 v[102:103], v12 offset:6400
    ds_read_b64_tr_b16 v[104:105], v12 offset:14336
    ds_read_b64_tr_b16 v[106:107], v12 offset:14592
    ds_read_b64_tr_b16 v[108:109], v12 offset:22528
    ds_read_b64_tr_b16 v[110:111], v12 offset:22784
    s_waitcnt lgkmcnt(7)
    v_mfma_f32_32x32x16_bf16 v[16:31], v[88:91], v[80:83], v[16:31]
    v_mfma_f32_16x16x32_bf16 v[64:67], v[88:91], v[76:79], v[64:67]
    v_mfma_f32_32x32x16_bf16 v[32:47], v[92:95], v[80:83], v[32:47]
    v_mfma_f32_16x16x32_bf16 v[68:71], v[92:95], v[76:79], v[68:71]
    v_mfma_f32_32x32x16_bf16 v[48:63], v[80:83], v[96:99], v[48:63]
    v_mfma_f32_16x16x32_bf16 v[72:75], v[96:99], v[76:79], v[72:75]
    s_waitcnt lgkmcnt(0)
    s_barrier
    ds_read_b128 v[80:83], v7 offset:8192
    ds_read_b64_tr_b16 v[88:89], v11 offset:24576
    ds_read_b64_tr_b16 v[90:91], v11 offset:24832
    ds_read_b64_tr_b16 v[92:93], v11 offset:32768
    ds_read_b64_tr_b16 v[94:95], v11 offset:33024
    ds_read_b64_tr_b16 v[96:97], v11 offset:40960
    ds_read_b64_tr_b16 v[98:99], v11 offset:41216
    s_waitcnt lgkmcnt(7)
    v_mfma_f32_32x32x16_bf16 v[16:31], v[100:103], v[84:87], v[16:31]
    v_mfma_f32_32x32x16_bf16 v[32:47], v[104:107], v[84:87], v[32:47]
    v_mfma_f32_32x32x16_bf16 v[48:63], v[84:87], v[108:111], v[48:63]
    ds_read_b128 v[84:87], v8 offset:8192
    ds_read_b64_tr_b16 v[100:101], v12 offset:26624
    ds_read_b64_tr_b16 v[102:103], v12 offset:26880
    ds_read_b64_tr_b16 v[104:105], v12 offset:34816
    ds_read_b64_tr_b16 v[106:107], v12 offset:35072
    ds_read_b64_tr_b16 v[108:109], v12 offset:43008
    ds_read_b64_tr_b16 v[110:111], v12 offset:43264
    s_waitcnt lgkmcnt(7)
    v_mfma_f32_32x32x16_bf16 v[16:31], v[88:91], v[80:83], v[16:31]
    v_mfma_f32_16x16x32_bf16 v[64:67], v[88:91], v[76:79], v[64:67]
    v_mfma_f32_32x32x16_bf16 v[32:47], v[92:95], v[80:83], v[32:47]
    v_mfma_f32_16x16x32_bf16 v[68:71], v[92:95], v[76:79], v[68:71]
    v_mfma_f32_32x32x16_bf16 v[48:63], v[80:83], v[96:99], v[48:63]
    v_mfma_f32_16x16x32_bf16 v[72:75], v[96:99], v[76:79], v[72:75]
    ds_read_b128 v[80:83], v9 offset:8192
    ds_read_b64_tr_b16 v[88:89], v11 offset:28672
    ds_read_b64_tr_b16 v[90:91], v11 offset:28928
    ds_read_b64_tr_b16 v[92:93], v11 offset:36864
    ds_read_b64_tr_b16 v[94:95], v11 offset:37120
    ds_read_b64_tr_b16 v[96:97], v11 offset:45056
    ds_read_b64_tr_b16 v[98:99], v11 offset:45312
    s_waitcnt lgkmcnt(7)
    v_mfma_f32_32x32x16_bf16 v[16:31], v[100:103], v[84:87], v[16:31]
    v_mfma_f32_32x32x16_bf16 v[32:47], v[104:107], v[84:87], v[32:47]
    v_mfma_f32_32x32x16_bf16 v[48:63], v[84:87], v[108:111], v[48:63]
    ds_read_b128 v[84:87], v10 offset:8192
    ds_read_b64_tr_b16 v[100:101], v12 offset:30720
    ds_read_b64_tr_b16 v[102:103], v12 offset:30976
    ds_read_b64_tr_b16 v[104:105], v12 offset:38912
    ds_read_b64_tr_b16 v[106:107], v12 offset:39168
    ds_read_b64_tr_b16 v[108:109], v12 offset:47104
    ds_read_b64_tr_b16 v[110:111], v12 offset:47360
    s_waitcnt lgkmcnt(7)
    v_mfma_f32_32x32x16_bf16 v[16:31], v[88:91], v[80:83], v[16:31]
    v_mfma_f32_16x16x32_bf16 v[64:67], v[88:91], v[76:79], v[64:67]
    v_mfma_f32_32x32x16_bf16 v[32:47], v[92:95], v[80:83], v[32:47]
    v_mfma_f32_16x16x32_bf16 v[68:71], v[92:95], v[76:79], v[68:71]
    v_mfma_f32_32x32x16_bf16 v[48:63], v[80:83], v[96:99], v[48:63]
    v_mfma_f32_16x16x32_bf16 v[72:75], v[96:99], v[76:79], v[72:75]
    s_waitcnt lgkmcnt(0)
    s_barrier
    ds_read_b128 v[80:83], v7 offset:16384
    ds_read_b64_tr_b16 v[88:89], v13 offset:0
    ds_read_b64_tr_b16 v[90:91], v13 offset:256
    ds_read_b64_tr_b16 v[92:93], v13 offset:8192
    ds_read_b64_tr_b16 v[94:95], v13 offset:8448
    ds_read_b64_tr_b16 v[96:97], v13 offset:16384
    ds_read_b64_tr_b16 v[98:99], v13 offset:16640
    s_waitcnt lgkmcnt(7)
    v_mfma_f32_32x32x16_bf16 v[16:31], v[100:103], v[84:87], v[16:31]
    v_mfma_f32_32x32x16_bf16 v[32:47], v[104:107], v[84:87], v[32:47]
    v_mfma_f32_32x32x16_bf16 v[48:63], v[84:87], v[108:111], v[48:63]
    ds_read_b128 v[84:87], v8 offset:16384
    ds_read_b64_tr_b16 v[100:101], v14 offset:2048
    ds_read_b64_tr_b16 v[102:103], v14 offset:2304
    ds_read_b64_tr_b16 v[104:105], v14 offset:10240
    ds_read_b64_tr_b16 v[106:107], v14 offset:10496
    ds_read_b64_tr_b16 v[108:109], v14 offset:18432
    ds_read_b64_tr_b16 v[110:111], v14 offset:18688
    s_waitcnt lgkmcnt(7)
    v_mfma_f32_32x32x16_bf16 v[16:31], v[88:91], v[80:83], v[16:31]
    v_mfma_f32_16x16x32_bf16 v[64:67], v[88:91], v[76:79], v[64:67]
    v_mfma_f32_32x32x16_bf16 v[32:47], v[92:95], v[80:83], v[32:47]
    v_mfma_f32_16x16x32_bf16 v[68:71], v[92:95], v[76:79], v[68:71]
    v_mfma_f32_32x32x16_bf16 v[48:63], v[80:83], v[96:99], v[48:63]
    v_mfma_f32_16x16x32_bf16 v[72:75], v[96:99], v[76:79], v[72:75]
    ds_read_b128 v[80:83], v9 offset:16384
    ds_read_b64_tr_b16 v[88:89], v13 offset:4096
    ds_read_b64_tr_b16 v[90:91], v13 offset:4352
    ds_read_b64_tr_b16 v[92:93], v13 offset:12288
    ds_read_b64_tr_b16 v[94:95], v13 offset:12544
    ds_read_b64_tr_b16 v[96:97], v13 offset:20480
    ds_read_b64_tr_b16 v[98:99], v13 offset:20736
    s_waitcnt lgkmcnt(7)
    v_mfma_f32_32x32x16_bf16 v[16:31], v[100:103], v[84:87], v[16:31]
    v_mfma_f32_32x32x16_bf16 v[32:47], v[104:107], v[84:87], v[32:47]
    v_mfma_f32_32x32x16_bf16 v[48:63], v[84:87], v[108:111], v[48:63]
    ds_read_b128 v[84:87], v10 offset:16384
    ds_read_b64_tr_b16 v[100:101], v14 offset:6144
    ds_read_b64_tr_b16 v[102:103], v14 offset:6400
    ds_read_b64_tr_b16 v[104:105], v14 offset:14336
    ds_read_b64_tr_b16 v[106:107], v14 offset:14592
    ds_read_b64_tr_b16 v[108:109], v14 offset:22528
    ds_read_b64_tr_b16 v[110:111], v14 offset:22784
    s_waitcnt lgkmcnt(7)
    v_mfma_f32_32x32x16_bf16 v[16:31], v[88:91], v[80:83], v[16:31]
    v_mfma_f32_16x16x32_bf16 v[64:67], v[88:91], v[76:79], v[64:67]
    v_mfma_f32_32x32x16_bf16 v[32:47], v[92:95], v[80:83], v[32:47]
    v_mfma_f32_16x16x32_bf16 v[68:71], v[92:95], v[76:79], v[68:71]
    v_mfma_f32_32x32x16_bf16 v[48:63], v[80:83], v[96:99], v[48:63]
    v_mfma_f32_16x16x32_bf16 v[72:75], v[96:99], v[76:79], v[72:75]
    s_waitcnt lgkmcnt(0)
    s_barrier
    ds_read_b128 v[80:83], v7 offset:24576
    ds_read_b64_tr_b16 v[88:89], v13 offset:24576
    ds_read_b64_tr_b16 v[90:91], v13 offset:24832
    ds_read_b64_tr_b16 v[92:93], v13 offset:32768
    ds_read_b64_tr_b16 v[94:95], v13 offset:33024
    ds_read_b64_tr_b16 v[96:97], v13 offset:40960
    ds_read_b64_tr_b16 v[98:99], v13 offset:41216
    s_waitcnt lgkmcnt(7)
    v_mfma_f32_32x32x16_bf16 v[16:31], v[100:103], v[84:87], v[16:31]
    v_mfma_f32_32x32x16_bf16 v[32:47], v[104:107], v[84:87], v[32:47]
    v_mfma_f32_32x32x16_bf16 v[48:63], v[84:87], v[108:111], v[48:63]
    ds_read_b128 v[84:87], v8 offset:24576
    ds_read_b64_tr_b16 v[100:101], v14 offset:26624
    ds_read_b64_tr_b16 v[102:103], v14 offset:26880
    ds_read_b64_tr_b16 v[104:105], v14 offset:34816
    ds_read_b64_tr_b16 v[106:107], v14 offset:35072
    ds_read_b64_tr_b16 v[108:109], v14 offset:43008
    ds_read_b64_tr_b16 v[110:111], v14 offset:43264
    s_waitcnt lgkmcnt(7)
    v_mfma_f32_32x32x16_bf16 v[16:31], v[88:91], v[80:83], v[16:31]
    v_mfma_f32_16x16x32_bf16 v[64:67], v[88:91], v[76:79], v[64:67]
    v_mfma_f32_32x32x16_bf16 v[32:47], v[92:95], v[80:83], v[32:47]
    v_mfma_f32_16x16x32_bf16 v[68:71], v[92:95], v[76:79], v[68:71]
    v_mfma_f32_32x32x16_bf16 v[48:63], v[80:83], v[96:99], v[48:63]
    v_mfma_f32_16x16x32_bf16 v[72:75], v[96:99], v[76:79], v[72:75]
    ds_read_b128 v[80:83], v9 offset:24576
    ds_read_b64_tr_b16 v[88:89], v13 offset:28672
    ds_read_b64_tr_b16 v[90:91], v13 offset:28928
    ds_read_b64_tr_b16 v[92:93], v13 offset:36864
    ds_read_b64_tr_b16 v[94:95], v13 offset:37120
    ds_read_b64_tr_b16 v[96:97], v13 offset:45056
    ds_read_b64_tr_b16 v[98:99], v13 offset:45312
    s_waitcnt lgkmcnt(7)
    v_mfma_f32_32x32x16_bf16 v[16:31], v[100:103], v[84:87], v[16:31]
    v_mfma_f32_32x32x16_bf16 v[32:47], v[104:107], v[84:87], v[32:47]
    v_mfma_f32_32x32x16_bf16 v[48:63], v[84:87], v[108:111], v[48:63]
    ds_read_b128 v[84:87], v10 offset:24576
    ds_read_b64_tr_b16 v[100:101], v14 offset:30720
    ds_read_b64_tr_b16 v[102:103], v14 offset:30976
    ds_read_b64_tr_b16 v[104:105], v14 offset:38912
    ds_read_b64_tr_b16 v[106:107], v14 offset:39168
    ds_read_b64_tr_b16 v[108:109], v14 offset:47104
    ds_read_b64_tr_b16 v[110:111], v14 offset:47360
    s_waitcnt lgkmcnt(7)
    v_mfma_f32_32x32x16_bf16 v[16:31], v[88:91], v[80:83], v[16:31]
    v_mfma_f32_16x16x32_bf16 v[64:67], v[88:91], v[76:79], v[64:67]
    v_mfma_f32_32x32x16_bf16 v[32:47], v[92:95], v[80:83], v[32:47]
    v_mfma_f32_16x16x32_bf16 v[68:71], v[92:95], v[76:79], v[68:71]
    v_mfma_f32_32x32x16_bf16 v[48:63], v[80:83], v[96:99], v[48:63]
    v_mfma_f32_16x16x32_bf16 v[72:75], v[96:99], v[76:79], v[72:75]
    s_waitcnt lgkmcnt(0)
    s_barrier
    ds_read_b128 v[80:83], v7 offset:0
    ds_read_b64_tr_b16 v[88:89], v11 offset:0
    ds_read_b64_tr_b16 v[90:91], v11 offset:256
    ds_read_b64_tr_b16 v[92:93], v11 offset:8192
    ds_read_b64_tr_b16 v[94:95], v11 offset:8448
    ds_read_b64_tr_b16 v[96:97], v11 offset:16384
    ds_read_b64_tr_b16 v[98:99], v11 offset:16640
    s_waitcnt lgkmcnt(7)
    v_mfma_f32_32x32x16_bf16 v[16:31], v[100:103], v[84:87], v[16:31]
    v_mfma_f32_32x32x16_bf16 v[32:47], v[104:107], v[84:87], v[32:47]
    v_mfma_f32_32x32x16_bf16 v[48:63], v[84:87], v[108:111], v[48:63]
    ds_read_b128 v[84:87], v8 offset:0
    ds_read_b64_tr_b16 v[100:101], v12 offset:2048
    ds_read_b64_tr_b16 v[102:103], v12 offset:2304
    ds_read_b64_tr_b16 v[104:105], v12 offset:10240
    ds_read_b64_tr_b16 v[106:107], v12 offset:10496
    ds_read_b64_tr_b16 v[108:109], v12 offset:18432
    ds_read_b64_tr_b16 v[110:111], v12 offset:18688
    s_waitcnt lgkmcnt(7)
    v_mfma_f32_32x32x16_bf16 v[16:31], v[88:91], v[80:83], v[16:31]
    v_mfma_f32_16x16x32_bf16 v[64:67], v[88:91], v[76:79], v[64:67]
    v_mfma_f32_32x32x16_bf16 v[32:47], v[92:95], v[80:83], v[32:47]
    v_mfma_f32_16x16x32_bf16 v[68:71], v[92:95], v[76:79], v[68:71]
    v_mfma_f32_32x32x16_bf16 v[48:63], v[80:83], v[96:99], v[48:63]
    v_mfma_f32_16x16x32_bf16 v[72:75], v[96:99], v[76:79], v[72:75]
    ds_read_b128 v[80:83], v9 offset:0
    ds_read_b64_tr_b16 v[88:89], v11 offset:4096
    ds_read_b64_tr_b16 v[90:91], v11 offset:4352
    ds_read_b64_tr_b16 v[92:93], v11 offset:12288
    ds_read_b64_tr_b16 v[94:95], v11 offset:12544
    ds_read_b64_tr_b16 v[96:97], v11 offset:20480
    ds_read_b64_tr_b16 v[98:99], v11 offset:20736
    s_waitcnt lgkmcnt(7)
    v_mfma_f32_32x32x16_bf16 v[16:31], v[100:103], v[84:87], v[16:31]
    v_mfma_f32_32x32x16_bf16 v[32:47], v[104:107], v[84:87], v[32:47]
    v_mfma_f32_32x32x16_bf16 v[48:63], v[84:87], v[108:111], v[48:63]
    ds_read_b128 v[84:87], v10 offset:0
    ds_read_b64_tr_b16 v[100:101], v12 offset:6144
    ds_read_b64_tr_b16 v[102:103], v12 offset:6400
    ds_read_b64_tr_b16 v[104:105], v12 offset:14336
    ds_read_b64_tr_b16 v[106:107], v12 offset:14592
    ds_read_b64_tr_b16 v[108:109], v12 offset:22528
    ds_read_b64_tr_b16 v[110:111], v12 offset:22784
    s_waitcnt lgkmcnt(7)
    v_mfma_f32_32x32x16_bf16 v[16:31], v[88:91], v[80:83], v[16:31]
    v_mfma_f32_16x16x32_bf16 v[64:67], v[88:91], v[76:79], v[64:67]
    v_mfma_f32_32x32x16_bf16 v[32:47], v[92:95], v[80:83], v[32:47]
    v_mfma_f32_16x16x32_bf16 v[68:71], v[92:95], v[76:79], v[68:71]
    v_mfma_f32_32x32x16_bf16 v[48:63], v[80:83], v[96:99], v[48:63]
    v_mfma_f32_16x16x32_bf16 v[72:75], v[96:99], v[76:79], v[72:75]
    s_waitcnt lgkmcnt(0)
    s_barrier
    ds_read_b128 v[80:83], v7 offset:8192
    ds_read_b64_tr_b16 v[88:89], v11 offset:24576
    ds_read_b64_tr_b16 v[90:91], v11 offset:24832
    ds_read_b64_tr_b16 v[92:93], v11 offset:32768
    ds_read_b64_tr_b16 v[94:95], v11 offset:33024
    ds_read_b64_tr_b16 v[96:97], v11 offset:40960
    ds_read_b64_tr_b16 v[98:99], v11 offset:41216
    s_waitcnt lgkmcnt(7)
    v_mfma_f32_32x32x16_bf16 v[16:31], v[100:103], v[84:87], v[16:31]
    v_mfma_f32_32x32x16_bf16 v[32:47], v[104:107], v[84:87], v[32:47]
    v_mfma_f32_32x32x16_bf16 v[48:63], v[84:87], v[108:111], v[48:63]
    ds_read_b128 v[84:87], v8 offset:8192
    ds_read_b64_tr_b16 v[100:101], v12 offset:26624
    ds_read_b64_tr_b16 v[102:103], v12 offset:26880
    ds_read_b64_tr_b16 v[104:105], v12 offset:34816
    ds_read_b64_tr_b16 v[106:107], v12 offset:35072
    ds_read_b64_tr_b16 v[108:109], v12 offset:43008
    ds_read_b64_tr_b16 v[110:111], v12 offset:43264
    s_waitcnt lgkmcnt(7)
    v_mfma_f32_32x32x16_bf16 v[16:31], v[88:91], v[80:83], v[16:31]
    v_mfma_f32_16x16x32_bf16 v[64:67], v[88:91], v[76:79], v[64:67]
    v_mfma_f32_32x32x16_bf16 v[32:47], v[92:95], v[80:83], v[32:47]
    v_mfma_f32_16x16x32_bf16 v[68:71], v[92:95], v[76:79], v[68:71]
    v_mfma_f32_32x32x16_bf16 v[48:63], v[80:83], v[96:99], v[48:63]
    v_mfma_f32_16x16x32_bf16 v[72:75], v[96:99], v[76:79], v[72:75]
    ds_read_b128 v[80:83], v9 offset:8192
    ds_read_b64_tr_b16 v[88:89], v11 offset:28672
    ds_read_b64_tr_b16 v[90:91], v11 offset:28928
    ds_read_b64_tr_b16 v[92:93], v11 offset:36864
    ds_read_b64_tr_b16 v[94:95], v11 offset:37120
    ds_read_b64_tr_b16 v[96:97], v11 offset:45056
    ds_read_b64_tr_b16 v[98:99], v11 offset:45312
    s_waitcnt lgkmcnt(7)
    v_mfma_f32_32x32x16_bf16 v[16:31], v[100:103], v[84:87], v[16:31]
    v_mfma_f32_32x32x16_bf16 v[32:47], v[104:107], v[84:87], v[32:47]
    v_mfma_f32_32x32x16_bf16 v[48:63], v[84:87], v[108:111], v[48:63]
    ds_read_b128 v[84:87], v10 offset:8192
    ds_read_b64_tr_b16 v[100:101], v12 offset:30720
    ds_read_b64_tr_b16 v[102:103], v12 offset:30976
    ds_read_b64_tr_b16 v[104:105], v12 offset:38912
    ds_read_b64_tr_b16 v[106:107], v12 offset:39168
    ds_read_b64_tr_b16 v[108:109], v12 offset:47104
    ds_read_b64_tr_b16 v[110:111], v12 offset:47360
    s_waitcnt lgkmcnt(7)
    v_mfma_f32_32x32x16_bf16 v[16:31], v[88:91], v[80:83], v[16:31]
    v_mfma_f32_16x16x32_bf16 v[64:67], v[88:91], v[76:79], v[64:67]
    v_mfma_f32_32x32x16_bf16 v[32:47], v[92:95], v[80:83], v[32:47]
    v_mfma_f32_16x16x32_bf16 v[68:71], v[92:95], v[76:79], v[68:71]
    v_mfma_f32_32x32x16_bf16 v[48:63], v[80:83], v[96:99], v[48:63]
    v_mfma_f32_16x16x32_bf16 v[72:75], v[96:99], v[76:79], v[72:75]
    s_waitcnt lgkmcnt(0)
    s_barrier
    ds_read_b128 v[80:83], v7 offset:16384
    ds_read_b64_tr_b16 v[88:89], v13 offset:0
    ds_read_b64_tr_b16 v[90:91], v13 offset:256
    ds_read_b64_tr_b16 v[92:93], v13 offset:8192
    ds_read_b64_tr_b16 v[94:95], v13 offset:8448
    ds_read_b64_tr_b16 v[96:97], v13 offset:16384
    ds_read_b64_tr_b16 v[98:99], v13 offset:16640
    s_waitcnt lgkmcnt(7)
    v_mfma_f32_32x32x16_bf16 v[16:31], v[100:103], v[84:87], v[16:31]
    v_mfma_f32_32x32x16_bf16 v[32:47], v[104:107], v[84:87], v[32:47]
    v_mfma_f32_32x32x16_bf16 v[48:63], v[84:87], v[108:111], v[48:63]
    ds_read_b128 v[84:87], v8 offset:16384
    ds_read_b64_tr_b16 v[100:101], v14 offset:2048
    ds_read_b64_tr_b16 v[102:103], v14 offset:2304
    ds_read_b64_tr_b16 v[104:105], v14 offset:10240
    ds_read_b64_tr_b16 v[106:107], v14 offset:10496
    ds_read_b64_tr_b16 v[108:109], v14 offset:18432
    ds_read_b64_tr_b16 v[110:111], v14 offset:18688
    s_waitcnt lgkmcnt(7)
    v_mfma_f32_32x32x16_bf16 v[16:31], v[88:91], v[80:83], v[16:31]
    v_mfma_f32_16x16x32_bf16 v[64:67], v[88:91], v[76:79], v[64:67]
    v_mfma_f32_32x32x16_bf16 v[32:47], v[92:95], v[80:83], v[32:47]
    v_mfma_f32_16x16x32_bf16 v[68:71], v[92:95], v[76:79], v[68:71]
    v_mfma_f32_32x32x16_bf16 v[48:63], v[80:83], v[96:99], v[48:63]
    v_mfma_f32_16x16x32_bf16 v[72:75], v[96:99], v[76:79], v[72:75]
    ds_read_b128 v[80:83], v9 offset:16384
    ds_read_b64_tr_b16 v[88:89], v13 offset:4096
    ds_read_b64_tr_b16 v[90:91], v13 offset:4352
    ds_read_b64_tr_b16 v[92:93], v13 offset:12288
    ds_read_b64_tr_b16 v[94:95], v13 offset:12544
    ds_read_b64_tr_b16 v[96:97], v13 offset:20480
    ds_read_b64_tr_b16 v[98:99], v13 offset:20736
    s_waitcnt lgkmcnt(7)
    v_mfma_f32_32x32x16_bf16 v[16:31], v[100:103], v[84:87], v[16:31]
    v_mfma_f32_32x32x16_bf16 v[32:47], v[104:107], v[84:87], v[32:47]
    v_mfma_f32_32x32x16_bf16 v[48:63], v[84:87], v[108:111], v[48:63]
    ds_read_b128 v[84:87], v10 offset:16384
    ds_read_b64_tr_b16 v[100:101], v14 offset:6144
    ds_read_b64_tr_b16 v[102:103], v14 offset:6400
    ds_read_b64_tr_b16 v[104:105], v14 offset:14336
    ds_read_b64_tr_b16 v[106:107], v14 offset:14592
    ds_read_b64_tr_b16 v[108:109], v14 offset:22528
    ds_read_b64_tr_b16 v[110:111], v14 offset:22784
    s_waitcnt lgkmcnt(7)
    v_mfma_f32_32x32x16_bf16 v[16:31], v[88:91], v[80:83], v[16:31]
    v_mfma_f32_16x16x32_bf16 v[64:67], v[88:91], v[76:79], v[64:67]
    v_mfma_f32_32x32x16_bf16 v[32:47], v[92:95], v[80:83], v[32:47]
    v_mfma_f32_16x16x32_bf16 v[68:71], v[92:95], v[76:79], v[68:71]
    v_mfma_f32_32x32x16_bf16 v[48:63], v[80:83], v[96:99], v[48:63]
    v_mfma_f32_16x16x32_bf16 v[72:75], v[96:99], v[76:79], v[72:75]
    s_waitcnt lgkmcnt(0)
    s_barrier
    ds_read_b128 v[80:83], v7 offset:24576
    ds_read_b64_tr_b16 v[88:89], v13 offset:24576
    ds_read_b64_tr_b16 v[90:91], v13 offset:24832
    ds_read_b64_tr_b16 v[92:93], v13 offset:32768
    ds_read_b64_tr_b16 v[94:95], v13 offset:33024
    ds_read_b64_tr_b16 v[96:97], v13 offset:40960
    ds_read_b64_tr_b16 v[98:99], v13 offset:41216
    s_waitcnt lgkmcnt(7)
    v_mfma_f32_32x32x16_bf16 v[16:31], v[100:103], v[84:87], v[16:31]
    v_mfma_f32_32x32x16_bf16 v[32:47], v[104:107], v[84:87], v[32:47]
    v_mfma_f32_32x32x16_bf16 v[48:63], v[84:87], v[108:111], v[48:63]
    ds_read_b128 v[84:87], v8 offset:24576
    ds_read_b64_tr_b16 v[100:101], v14 offset:26624
    ds_read_b64_tr_b16 v[102:103], v14 offset:26880
    ds_read_b64_tr_b16 v[104:105], v14 offset:34816
    ds_read_b64_tr_b16 v[106:107], v14 offset:35072
    ds_read_b64_tr_b16 v[108:109], v14 offset:43008
    ds_read_b64_tr_b16 v[110:111], v14 offset:43264
    s_waitcnt lgkmcnt(7)
    v_mfma_f32_32x32x16_bf16 v[16:31], v[88:91], v[80:83], v[16:31]
    v_mfma_f32_16x16x32_bf16 v[64:67], v[88:91], v[76:79], v[64:67]
    v_mfma_f32_32x32x16_bf16 v[32:47], v[92:95], v[80:83], v[32:47]
    v_mfma_f32_16x16x32_bf16 v[68:71], v[92:95], v[76:79], v[68:71]
    v_mfma_f32_32x32x16_bf16 v[48:63], v[80:83], v[96:99], v[48:63]
    v_mfma_f32_16x16x32_bf16 v[72:75], v[96:99], v[76:79], v[72:75]
    ds_read_b128 v[80:83], v9 offset:24576
    ds_read_b64_tr_b16 v[88:89], v13 offset:28672
    ds_read_b64_tr_b16 v[90:91], v13 offset:28928
    ds_read_b64_tr_b16 v[92:93], v13 offset:36864
    ds_read_b64_tr_b16 v[94:95], v13 offset:37120
    ds_read_b64_tr_b16 v[96:97], v13 offset:45056
    ds_read_b64_tr_b16 v[98:99], v13 offset:45312
    s_waitcnt lgkmcnt(7)
    v_mfma_f32_32x32x16_bf16 v[16:31], v[100:103], v[84:87], v[16:31]
    v_mfma_f32_32x32x16_bf16 v[32:47], v[104:107], v[84:87], v[32:47]
    v_mfma_f32_32x32x16_bf16 v[48:63], v[84:87], v[108:111], v[48:63]
    ds_read_b128 v[84:87], v10 offset:24576
    ds_read_b64_tr_b16 v[100:101], v14 offset:30720
    ds_read_b64_tr_b16 v[102:103], v14 offset:30976
    ds_read_b64_tr_b16 v[104:105], v14 offset:38912
    ds_read_b64_tr_b16 v[106:107], v14 offset:39168
    ds_read_b64_tr_b16 v[108:109], v14 offset:47104
    ds_read_b64_tr_b16 v[110:111], v14 offset:47360
    s_waitcnt lgkmcnt(7)
    v_mfma_f32_32x32x16_bf16 v[16:31], v[88:91], v[80:83], v[16:31]
    v_mfma_f32_16x16x32_bf16 v[64:67], v[88:91], v[76:79], v[64:67]
    v_mfma_f32_32x32x16_bf16 v[32:47], v[92:95], v[80:83], v[32:47]
    v_mfma_f32_16x16x32_bf16 v[68:71], v[92:95], v[76:79], v[68:71]
    v_mfma_f32_32x32x16_bf16 v[48:63], v[80:83], v[96:99], v[48:63]
    v_mfma_f32_16x16x32_bf16 v[72:75], v[96:99], v[76:79], v[72:75]
    s_waitcnt lgkmcnt(0)
    v_mfma_f32_32x32x16_bf16 v[16:31], v[100:103], v[84:87], v[16:31]
    v_mfma_f32_32x32x16_bf16 v[32:47], v[104:107], v[84:87], v[32:47]
    v_mfma_f32_32x32x16_bf16 v[48:63], v[84:87], v[108:111], v[48:63]
    v_and_b32 v2, 15, v1
    v_lshrrev_b32 v3, 4, v1
    v_lshlrev_b32 v3, 4, v3
    v_lshl_add_u32 v3, v2, 6, v3
    s_mul_i32 s37, s39, 768
    s_lshl_b32 s38, s40, 7
    s_add_u32 s37, s37, s38
    s_add_u32 s37, s37, 131072
    v_add_u32 v3, s37, v3
    v_cmp_gt_u32 vcc, 2, v2
    s_nop 0
    s_and_saveexec_b64 s[60:61], vcc
    ds_write_b128 v3, v[64:67] offset:0
    ds_write_b128 v3, v[68:71] offset:256
    ds_write_b128 v3, v[72:75] offset:512
    s_mov_b64 exec, s[60:61]
    s_waitcnt lgkmcnt(0)
    s_barrier
    s_lshl_b32 s37, s39, 8
    s_add_u32 s37, s37, 132608
    v_lshl_add_u32 v3, v6, 2, s37
    ds_read_b32 v136, v3
    ds_read_b32 v137, v3 offset:512
    ds_read_b32 v138, v3 offset:128
    ds_read_b32 v139, v3 offset:640
    s_lshl_b32 s38, s40, 7
    s_add_u32 s38, s38, 131072
    v_lshl_add_u32 v2, v5, 4, s38
    ds_read_b128 v[64:67], v2 offset:0
    ds_read_b128 v[68:71], v2 offset:32
    ds_read_b128 v[72:75], v2 offset:64
    ds_read_b128 v[76:79], v2 offset:96
    ds_read_b128 v[96:99], v2 offset:768
    ds_read_b128 v[100:103], v2 offset:800
    ds_read_b128 v[104:107], v2 offset:832
    ds_read_b128 v[108:111], v2 offset:864
    s_waitcnt lgkmcnt(4)
    ds_read_b128 v[80:83], v2 offset:256
    ds_read_b128 v[84:87], v2 offset:288
    ds_read_b128 v[88:91], v2 offset:320
    ds_read_b128 v[92:95], v2 offset:352
    ds_read_b128 v[112:115], v2 offset:1024
    ds_read_b128 v[116:119], v2 offset:1056
    ds_read_b128 v[120:123], v2 offset:1088
    ds_read_b128 v[124:127], v2 offset:1120
    v_lshl_add_u32 v3, v6, 2, s38
    ds_read_b32 v128, v3 offset:512
    ds_read_b32 v140, v3 offset:1280
    s_waitcnt lgkmcnt(10)
    v_add_f32 v64, v64, v96
    v_add_f32 v65, v65, v97
    v_add_f32 v66, v66, v98
    v_add_f32 v67, v67, v99
    v_add_f32 v68, v68, v100
    v_add_f32 v69, v69, v101
    v_add_f32 v70, v70, v102
    v_add_f32 v71, v71, v103
    v_add_f32 v72, v72, v104
    v_add_f32 v73, v73, v105
    v_add_f32 v74, v74, v106
    v_add_f32 v75, v75, v107
    v_add_f32 v76, v76, v108
    v_add_f32 v77, v77, v109
    v_add_f32 v78, v78, v110
    v_add_f32 v79, v79, v111
    s_waitcnt lgkmcnt(0)
    v_add_f32 v80, v80, v112
    v_add_f32 v81, v81, v113
    v_add_f32 v82, v82, v114
    v_add_f32 v83, v83, v115
    v_add_f32 v84, v84, v116
    v_add_f32 v85, v85, v117
    v_add_f32 v86, v86, v118
    v_add_f32 v87, v87, v119
    v_add_f32 v88, v88, v120
    v_add_f32 v89, v89, v121
    v_add_f32 v90, v90, v122
    v_add_f32 v91, v91, v123
    v_add_f32 v92, v92, v124
    v_add_f32 v93, v93, v125
    v_add_f32 v94, v94, v126
    v_add_f32 v95, v95, v127
    v_add_f32 v128, v128, v140
    v_lshlrev_b32 v131, 4, v1
    v_add_f32 v136, v136, v137
    v_add_f32 v138, v138, v139
    v_mul_f32 v129, 0x3b000000, v136
    v_mul_f32 v3, v129, v129
    v_mov_b32 v4, 0x3b000000
    v_fma_f32 v3, v138, v4, -v3
    v_max_f32 v3, 0, v3
    v_add_f32 v3, 0x3727c5ac, v3
    v_rsq_f32 v130, v3
    s_nop 0
    v_mul_f32 v137, v129, v130
    s_lshl_b32 s37, s25, 8
    s_add_u32 s37, s37, 133632
    v_lshl_add_u32 v3, v6, 2, s37
    ds_write_b32 v3, v137
    ds_write_b32 v3, v130 offset:128
    v_lshl_add_u32 v2, v5, 4, s37
    v_mul_f32 v132, 0x3eb8aa3b, v130
    s_waitcnt lgkmcnt(0)
    ds_read_b128 v[96:99], v2 offset:0
    ds_read_b128 v[100:103], v2 offset:32
    ds_read_b128 v[104:107], v2 offset:64
    ds_read_b128 v[108:111], v2 offset:96
    ds_read_b128 v[112:115], v2 offset:128
    ds_read_b128 v[116:119], v2 offset:160
    ds_read_b128 v[120:123], v2 offset:192
    ds_read_b128 v[124:127], v2 offset:224
    v_fma_f32 v16, -v129, v64, v16
    v_fma_f32 v17, -v129, v65, v17
    v_fma_f32 v18, -v129, v66, v18
    v_fma_f32 v19, -v129, v67, v19
    v_fma_f32 v20, -v129, v68, v20
    v_fma_f32 v21, -v129, v69, v21
    v_fma_f32 v22, -v129, v70, v22
    v_fma_f32 v23, -v129, v71, v23
    v_fma_f32 v24, -v129, v72, v24
    v_fma_f32 v25, -v129, v73, v25
    v_fma_f32 v26, -v129, v74, v26
    v_fma_f32 v27, -v129, v75, v27
    v_fma_f32 v28, -v129, v76, v28
    v_fma_f32 v29, -v129, v77, v29
    v_fma_f32 v30, -v129, v78, v30
    v_fma_f32 v31, -v129, v79, v31
    v_mul_f32 v16, v132, v16
    v_mul_f32 v17, v132, v17
    v_mul_f32 v18, v132, v18
    v_mul_f32 v19, v132, v19
    v_mul_f32 v20, v132, v20
    v_mul_f32 v21, v132, v21
    v_mul_f32 v22, v132, v22
    v_mul_f32 v23, v132, v23
    v_mul_f32 v24, v132, v24
    v_mul_f32 v25, v132, v25
    v_mul_f32 v26, v132, v26
    v_mul_f32 v27, v132, v27
    v_mul_f32 v28, v132, v28
    v_mul_f32 v29, v132, v29
    v_mul_f32 v30, v132, v30
    v_mul_f32 v31, v132, v31
    v_cvt_pk_bf16_f32 v144, v16, v17
    v_cvt_pk_bf16_f32 v145, v18, v19
    v_cvt_pk_bf16_f32 v146, v20, v21
    v_cvt_pk_bf16_f32 v147, v22, v23
    v_cvt_pk_bf16_f32 v148, v24, v25
    v_cvt_pk_bf16_f32 v149, v26, v27
    v_cvt_pk_bf16_f32 v150, v28, v29
    v_cvt_pk_bf16_f32 v151, v30, v31
    buffer_store_dwordx4 v[144:147], v131, s[20:23], s57 offen sc1
    s_add_u32 s31, s57, 65536
    buffer_store_dwordx4 v[148:151], v131, s[20:23], s31 offen sc1
    v_fma_f32 v32, -v129, v80, v32
    v_fma_f32 v33, -v129, v81, v33
    v_fma_f32 v34, -v129, v82, v34
    v_fma_f32 v35, -v129, v83, v35
    v_fma_f32 v36, -v129, v84, v36
    v_fma_f32 v37, -v129, v85, v37
    v_fma_f32 v38, -v129, v86, v38
    v_fma_f32 v39, -v129, v87, v39
    v_fma_f32 v40, -v129, v88, v40
    v_fma_f32 v41, -v129, v89, v41
    v_fma_f32 v42, -v129, v90, v42
    v_fma_f32 v43, -v129, v91, v43
    v_fma_f32 v44, -v129, v92, v44
    v_fma_f32 v45, -v129, v93, v45
    v_fma_f32 v46, -v129, v94, v46
    v_fma_f32 v47, -v129, v95, v47
    v_mul_f32 v32, v130, v32
    v_mul_f32 v33, v130, v33
    v_mul_f32 v34, v130, v34
    v_mul_f32 v35, v130, v35
    v_mul_f32 v36, v130, v36
    v_mul_f32 v37, v130, v37
    v_mul_f32 v38, v130, v38
    v_mul_f32 v39, v130, v39
    v_mul_f32 v40, v130, v40
    v_mul_f32 v41, v130, v41
    v_mul_f32 v42, v130, v42
    v_mul_f32 v43, v130, v43
    v_mul_f32 v44, v130, v44
    v_mul_f32 v45, v130, v45
    v_mul_f32 v46, v130, v46
    v_mul_f32 v47, v130, v47
    v_cvt_pk_bf16_f32 v152, v32, v33
    v_cvt_pk_bf16_f32 v153, v34, v35
    v_cvt_pk_bf16_f32 v154, v36, v37
    v_cvt_pk_bf16_f32 v155, v38, v39
    v_cvt_pk_bf16_f32 v156, v40, v41
    v_cvt_pk_bf16_f32 v157, v42, v43
    v_cvt_pk_bf16_f32 v158, v44, v45
    v_cvt_pk_bf16_f32 v159, v46, v47
    buffer_store_dwordx4 v[152:155], v131, s[20:23], s58 offen sc1
    s_add_u32 s31, s58, 65536
    buffer_store_dwordx4 v[156:159], v131, s[20:23], s31 offen sc1
    s_waitcnt lgkmcnt(0)
    v_mul_f32 v96, v128, v96
    v_mul_f32 v97, v128, v97
    v_mul_f32 v98, v128, v98
    v_mul_f32 v99, v128, v99
    v_mul_f32 v100, v128, v100
    v_mul_f32 v101, v128, v101
    v_mul_f32 v102, v128, v102
    v_mul_f32 v103, v128, v103
    v_mul_f32 v104, v128, v104
    v_mul_f32 v105, v128, v105
    v_mul_f32 v106, v128, v106
    v_mul_f32 v107, v128, v107
    v_mul_f32 v108, v128, v108
    v_mul_f32 v109, v128, v109
    v_mul_f32 v110, v128, v110
    v_mul_f32 v111, v128, v111
    v_fma_f32 v48, v48, v112, -v96
    v_fma_f32 v49, v49, v113, -v97
    v_fma_f32 v50, v50, v114, -v98
    v_fma_f32 v51, v51, v115, -v99
    v_fma_f32 v52, v52, v116, -v100
    v_fma_f32 v53, v53, v117, -v101
    v_fma_f32 v54, v54, v118, -v102
    v_fma_f32 v55, v55, v119, -v103
    v_fma_f32 v56, v56, v120, -v104
    v_fma_f32 v57, v57, v121, -v105
    v_fma_f32 v58, v58, v122, -v106
    v_fma_f32 v59, v59, v123, -v107
    v_fma_f32 v60, v60, v124, -v108
    v_fma_f32 v61, v61, v125, -v109
    v_fma_f32 v62, v62, v126, -v110
    v_fma_f32 v63, v63, v127, -v111
    v_cvt_pk_bf16_f32 v144, v48, v49
    v_cvt_pk_bf16_f32 v145, v50, v51
    v_cvt_pk_bf16_f32 v146, v52, v53
    v_cvt_pk_bf16_f32 v147, v54, v55
    v_cvt_pk_bf16_f32 v148, v56, v57
    v_cvt_pk_bf16_f32 v149, v58, v59
    v_cvt_pk_bf16_f32 v150, v60, v61
    v_cvt_pk_bf16_f32 v151, v62, v63
    v_lshrrev_b32 v2, 4, v6
    v_lshlrev_b32 v2, 16, v2
    v_lshl_add_u32 v2, v5, 8, v2
    v_and_b32 v3, 15, v6
    v_lshl_add_u32 v2, v3, 4, v2
    buffer_store_dwordx4 v[144:147], v2, s[20:23], s59 offen sc1
    buffer_store_dwordx4 v[148:151], v2, s[20:23], s59 offen offset:512 sc1
    v_lshlrev_b32 v64, 16, v152
    v_and_b32 v65, 0xffff0000, v152
    v_lshlrev_b32 v66, 16, v153
    v_and_b32 v67, 0xffff0000, v153
    v_lshlrev_b32 v68, 16, v154
    v_and_b32 v69, 0xffff0000, v154
    v_lshlrev_b32 v70, 16, v155
    v_and_b32 v71, 0xffff0000, v155
    v_mul_f32 v160, v64, v64
    v_fmac_f32 v160, v65, v65
    v_fmac_f32 v160, v66, v66
    v_fmac_f32 v160, v67, v67
    v_fmac_f32 v160, v68, v68
    v_fmac_f32 v160, v69, v69
    v_fmac_f32 v160, v70, v70
    v_fmac_f32 v160, v71, v71
    v_lshlrev_b32 v64, 16, v156
    v_and_b32 v65, 0xffff0000, v156
    v_lshlrev_b32 v66, 16, v157
    v_and_b32 v67, 0xffff0000, v157
    v_lshlrev_b32 v68, 16, v158
    v_and_b32 v69, 0xffff0000, v158
    v_lshlrev_b32 v70, 16, v159
    v_and_b32 v71, 0xffff0000, v159
    v_mul_f32 v161, v64, v64
    v_fmac_f32 v161, v65, v65
    v_fmac_f32 v161, v66, v66
    v_fmac_f32 v161, v67, v67
    v_fmac_f32 v161, v68, v68
    v_fmac_f32 v161, v69, v69
    v_fmac_f32 v161, v70, v70
    v_fmac_f32 v161, v71, v71
    v_mov_b32 v4, v160
    s_nop 1
    v_permlane32_swap_b32 v160, v4
    v_add_f32 v160, v160, v4
    v_mov_b32 v3, v161
    s_nop 1
    v_permlane32_swap_b32 v161, v3
    v_add_f32 v161, v161, v3
    v_max_f32_dpp v160, v160, v160 row_ror:8 row_mask:0xf bank_mask:0xf
    s_nop 0
    v_max_f32_dpp v161, v161, v161 row_ror:8 row_mask:0xf bank_mask:0xf
    v_max_f32_dpp v160, v160, v160 row_ror:4 row_mask:0xf bank_mask:0xf
    s_nop 0
    v_max_f32_dpp v161, v161, v161 row_ror:4 row_mask:0xf bank_mask:0xf
    v_max_f32_dpp v160, v160, v160 row_ror:2 row_mask:0xf bank_mask:0xf
    s_nop 0
    v_max_f32_dpp v161, v161, v161 row_ror:2 row_mask:0xf bank_mask:0xf
    v_max_f32_dpp v160, v160, v160 row_ror:1 row_mask:0xf bank_mask:0xf
    s_nop 0
    v_max_f32_dpp v161, v161, v161 row_ror:1 row_mask:0xf bank_mask:0xf
    v_readlane_b32 s62, v160, 0
    v_readlane_b32 s63, v160, 16
    v_readlane_b32 s64, v161, 0
    v_readlane_b32 s65, v161, 16
    s_max_u32 s62, s62, s63
    s_max_u32 s64, s64, s65
    s_lshl_b32 s31, s56, 9
    s_lshl_b32 s32, s55, 2
    s_add_u32 s31, s31, s32
    s_add_u32 s31, s31, 6291456
    v_mov_b32 v160, s62
    v_mov_b32 v161, s64
    v_mov_b32 v3, 0
    s_mov_b64 exec, 1
    buffer_store_dword v160, v3, s[20:23], s31 offen
    buffer_store_dword v161, v3, s[20:23], s31 offen offset:256
K1_END:
    s_endpgm
.globl km_fused_kernel
.p2align 8
.type km_fused_kernel,@function
km_fused_kernel:
    s_load_dwordx2 s[4:5], s[0:1], 80
    s_load_dwordx2 s[6:7], s[0:1], 0
    s_load_dwordx2 s[8:9], s[0:1], 16
    s_load_dwordx4 s[12:15], s[0:1], 32
    s_load_dwordx4 s[16:19], s[0:1], 48
    s_load_dwordx2 s[20:21], s[0:1], 64
    s_cmp_ge_u32 s2, 256
    s_cbranch_scc1 KM_END
    v_lshrrev_b32 v2, 6, v0
    v_and_b32 v1, 63, v0
    v_readfirstlane_b32 s36, v2
    s_nop 0
    s_and_b32 s37, s36, 3
    s_and_b32 s38, s2, 7
    s_lshr_b32 s39, s2, 3
    s_and_b32 s43, s39, 3
    s_lshr_b32 s44, s39, 2
    v_lshlrev_b32 v7, 4, v1
    v_lshrrev_b32 v5, 5, v1
    v_and_b32 v6, 31, v1
    s_lshl_b32 s50, s38, 2
    s_add_u32 s50, s50, s43
    s_mov_b32 s51, s36
    s_mov_b32 s52, 0
    s_lshl_b32 s53, s50, 16
    s_lshl_b32 s40, s44, 3
    s_mul_i32 s41, s51, 1
    s_add_u32 s56, s40, s41
    s_lshl_b32 s59, s36, 1
    s_lshl_b32 s42, s56, 10
    s_add_u32 s42, s42, s53
    v_lshlrev_b32 v4, 2, v1
    s_waitcnt lgkmcnt(0)
    s_mov_b32 s24, s4
    s_and_b32 s25, s5, 0xffff
    s_mov_b32 s26, 25165824
    s_mov_b32 s27, 0x20000
    s_mov_b32 s48, s38
    s_mov_b32 s49, s39
    buffer_load_dwordx4 v[20:23], v7, s[24:27], s42 offen offset:0
    s_lshl_b32 s40, s50, 8
    s_add_u32 s40, s40, 6291456
    buffer_load_dword v24, v4, s[24:27], s40 offen
    s_add_u32 s57, s59, 0
    s_lshl_b32 s40, s44, 3
    s_add_u32 s58, s57, s40
    s_and_b32 s58, s58, 63
    s_lshl_b32 s58, s58, 10
    s_add_u32 s58, s58, s53
    s_lshl_b32 s57, s57, 10
    s_add_u32 m0, s57, 0
    s_add_u32 s40, s58, 2097152
    buffer_load_dwordx4 v7, s[24:27], s40 offen lds
    buffer_load_dwordx4 v7, s[24:27], s40 offen offset:1024 lds
    s_add_u32 m0, s57, 65536
    s_add_u32 s40, s58, 4194304
    buffer_load_dwordx4 v7, s[24:27], s40 offen lds
    buffer_load_dwordx4 v7, s[24:27], s40 offen offset:1024 lds
    v_mov_b32 v3, 0x3f803f80
    v_lshlrev_b32 v2, 2, v0
    v_add_u32 v2, 131072, v2
    ds_write_b32 v2, v3
    ds_write_b32 v2, v3 offset:2048
    v_mov_b32 v4, 0
    ds_write_b32 v2, v4 offset:4608
    ds_write_b32 v2, v4 offset:6656
    v_cmp_gt_u32 vcc, 128, v0
    s_nop 0
    s_and_saveexec_b64 s[46:47], vcc
    ds_write_b32 v2, v3 offset:4096
    ds_write_b32 v2, v4 offset:8704
    s_mov_b64 exec, s[46:47]
    s_lshl_b32 s40, s52, 15
    v_add_u32 v16, s40, v7
    v_lshlrev_b32 v2, 8, v5
    v_lshl_add_u32 v2, v6, 4, v2
    s_add_u32 s40, s40, 65536
    v_add_u32 v2, s40, v2
    v_subrev_u32 v3, 20, v6
    v_cmp_gt_u32 vcc, 8, v3
    v_mov_b32 v3, 135872
    v_mov_b32 v4, 135744
    v_cndmask_b32 v3, v3, v4, vcc
    v_mov_b32 v4, 131072
    v_cmp_eq_u32 vcc, 16, v6
    s_nop 1
    v_cndmask_b32 v3, v3, v4, vcc
    v_cmp_gt_u32 vcc, 16, v6
    s_nop 1
    v_cndmask_b32 v17, v3, v2, vcc
    v_mov_b32 v3, 4096
    v_cndmask_b32 v18, 0, v3, vcc
    v_mov_b32 v92, 0
    v_mov_b32 v93, 0
    v_mov_b32 v94, 0
    v_mov_b32 v95, 0
    v_mov_b32 v96, 0
    v_mov_b32 v97, 0
    v_mov_b32 v98, 0
    v_mov_b32 v99, 0
    v_mov_b32 v100, 0
    v_mov_b32 v101, 0
    v_mov_b32 v102, 0
    v_mov_b32 v103, 0
    v_mov_b32 v104, 0
    v_mov_b32 v105, 0
    v_mov_b32 v106, 0
    v_mov_b32 v107, 0
    v_mov_b32 v88, 0
    v_mov_b32 v89, 0
    v_mov_b32 v90, 0
    v_mov_b32 v91, 0
    v_mov_b32 v48, 0
    v_mov_b32 v49, 0
    v_mov_b32 v50, 0
    v_mov_b32 v51, 0
    s_waitcnt vmcnt(4)
    v_max_f32_dpp v24, v24, v24 row_ror:8 row_mask:0xf bank_mask:0xf
    s_nop 1
    v_max_f32_dpp v24, v24, v24 row_ror:4 row_mask:0xf bank_mask:0xf
    s_nop 1
    v_max_f32_dpp v24, v24, v24 row_ror:2 row_mask:0xf bank_mask:0xf
    s_nop 1
    v_max_f32_dpp v24, v24, v24 row_ror:1 row_mask:0xf bank_mask:0xf
    s_nop 0
    v_readlane_b32 s55, v24, 0
    v_readlane_b32 s40, v24, 16
    s_nop 0
    s_max_u32 s55, s55, s40
    v_readlane_b32 s40, v24, 32
    s_nop 0
    s_max_u32 s55, s55, s40
    v_readlane_b32 s40, v24, 48
    s_nop 0
    s_max_u32 s55, s55, s40
    v_lshlrev_b32 v52, 16, v20
    v_and_b32 v53, 0xffff0000, v20
    v_lshlrev_b32 v54, 16, v21
    v_and_b32 v55, 0xffff0000, v21
    v_lshlrev_b32 v56, 16, v22
    v_and_b32 v57, 0xffff0000, v22
    v_lshlrev_b32 v58, 16, v23
    v_and_b32 v59, 0xffff0000, v23
    v_mul_f32 v2, v52, v52
    v_fmac_f32 v2, v53, v53
    v_fmac_f32 v2, v54, v54
    v_fmac_f32 v2, v55, v55
    v_fmac_f32 v2, v56, v56
    v_fmac_f32 v2, v57, v57
    v_fmac_f32 v2, v58, v58
    v_fmac_f32 v2, v59, v59
    v_mov_b32 v3, v2
    s_nop 1
    v_permlane32_swap_b32 v2, v3
    v_add_f32 v2, v2, v3
    v_mul_f32 v2, s55, v2
    v_sqrt_f32 v2, v2
    v_mov_b32 v3, 0x3c23d70a
    v_fmac_f32 v3, 0x3f8147ae, v2
    v_mov_b32 v4, 0x42200000
    v_cmp_nge_f32 vcc, v4, v3
    s_nop 0
    s_mov_b64 s[60:61], vcc
    v_sub_f32 v108, 0, v3
    v_sub_f32 v109, 0, v3
    v_sub_f32 v110, 0, v3
    v_sub_f32 v111, 0, v3
    v_sub_f32 v112, 0, v3
    v_sub_f32 v113, 0, v3
    v_sub_f32 v114, 0, v3
    v_sub_f32 v115, 0, v3
    v_sub_f32 v116, 0, v3
    v_sub_f32 v117, 0, v3
    v_sub_f32 v118, 0, v3
    v_sub_f32 v119, 0, v3
    v_sub_f32 v120, 0, v3
    v_sub_f32 v121, 0, v3
    v_sub_f32 v122, 0, v3
    v_sub_f32 v123, 0, v3
    s_waitcnt vmcnt(0) lgkmcnt(0)
    s_barrier
    s_lshl_b32 s40, s39, 2
    s_add_u32 s40, s40, s37
    s_cmp_lt_u32 s40, 72
    s_cselect_b32 s64, s12, s16
    s_cselect_b32 s65, s13, s17
    s_cselect_b32 s41, 16, 72
    s_cmp_lt_u32 s40, 16
    s_cselect_b32 s64, s8, s64
    s_cselect_b32 s65, s9, s65
    s_cselect_b32 s41, 0, s41
    s_sub_u32 s40, s40, s41
    s_lshl_b32 s40, s40, 15
    s_add_u32 s64, s64, s40
    s_addc_u32 s65, s65, 0
    s_and_b32 s65, s65, 0xffff
    s_mov_b32 s66, 32768
    s_mov_b32 s67, 0x20000
    s_mov_b32 s68, 0
    s_cmp_lt_u32 s36, 4
    s_cbranch_scc1 KM_OLD1
    s_lshl_b32 s57, s37, 2
    s_add_u32 s57, s57, 16
    s_lshl_b32 s40, s44, 3
    s_add_u32 s58, s57, s40
    s_and_b32 s58, s58, 63
    s_lshl_b32 s58, s58, 10
    s_add_u32 s58, s58, s53
    s_lshl_b32 s57, s57, 10
    s_add_u32 m0, s57, 0
    s_add_u32 s40, s58, 2097152
    buffer_load_dwordx4 v7, s[24:27], s40 offen offset:0 lds
    buffer_load_dwordx4 v7, s[24:27], s40 offen offset:1024 lds
    buffer_load_dwordx4 v7, s[24:27], s40 offen offset:2048 lds
    buffer_load_dwordx4 v7, s[24:27], s40 offen offset:3072 lds
    s_add_u32 m0, s57, 65536
    s_add_u32 s40, s58, 4194304
    buffer_load_dwordx4 v7, s[24:27], s40 offen offset:0 lds
    buffer_load_dwordx4 v7, s[24:27], s40 offen offset:1024 lds
    buffer_load_dwordx4 v7, s[24:27], s40 offen offset:2048 lds
    buffer_load_dwordx4 v7, s[24:27], s40 offen offset:3072 lds
    s_lshl_b32 s57, s37, 2
    s_add_u32 s57, s57, 32
    s_lshl_b32 s40, s44, 3
    s_add_u32 s58, s57, s40
    s_and_b32 s58, s58, 63
    s_lshl_b32 s58, s58, 10
    s_add_u32 s58, s58, s53
    s_lshl_b32 s57, s57, 10
    s_add_u32 m0, s57, 0
    s_add_u32 s40, s58, 2097152
    buffer_load_dwordx4 v7, s[24:27], s40 offen offset:0 lds
    buffer_load_dwordx4 v7, s[24:27], s40 offen offset:1024 lds
    buffer_load_dwordx4 v7, s[24:27], s40 offen offset:2048 lds
    buffer_load_dwordx4 v7, s[24:27], s40 offen offset:3072 lds
    s_add_u32 m0, s57, 65536
    s_add_u32 s40, s58, 4194304
    buffer_load_dwordx4 v7, s[24:27], s40 offen offset:0 lds
    buffer_load_dwordx4 v7, s[24:27], s40 offen offset:1024 lds
    buffer_load_dwordx4 v7, s[24:27], s40 offen offset:2048 lds
    buffer_load_dwordx4 v7, s[24:27], s40 offen offset:3072 lds
    s_lshl_b32 s57, s37, 2
    s_add_u32 s57, s57, 48
    s_lshl_b32 s40, s44, 3
    s_add_u32 s58, s57, s40
    s_and_b32 s58, s58, 63
    s_lshl_b32 s58, s58, 10
    s_add_u32 s58, s58, s53
    s_lshl_b32 s57, s57, 10
    s_add_u32 m0, s57, 0
    s_add_u32 s40, s58, 2097152
    buffer_load_dwordx4 v7, s[24:27], s40 offen offset:0 lds
    buffer_load_dwordx4 v7, s[24:27], s40 offen offset:1024 lds
    buffer_load_dwordx4 v7, s[24:27], s40 offen offset:2048 lds
    buffer_load_dwordx4 v7, s[24:27], s40 offen offset:3072 lds
    s_add_u32 m0, s57, 65536
    s_add_u32 s40, s58, 4194304
    buffer_load_dwordx4 v7, s[24:27], s40 offen offset:0 lds
    buffer_load_dwordx4 v7, s[24:27], s40 offen offset:1024 lds
    buffer_load_dwordx4 v7, s[24:27], s40 offen offset:2048 lds
    buffer_load_dwordx4 v7, s[24:27], s40 offen offset:3072 lds
    s_waitcnt vmcnt(0)
    s_barrier
    s_getpc_b64 s[70:71]
KM_PCREF:
    s_add_u32 s70, s70, KM_FIN-KM_PCREF
    s_addc_u32 s71, s71, 0
    s_mul_i32 s40, s37, 3072
    v_add_u32 v2, s40, v7
    global_load_dwordx4 v[124:127], v2, s[70:71] offset:0
    global_load_dwordx4 v[124:127], v2, s[70:71] offset:1024
    global_load_dwordx4 v[124:127], v2, s[70:71] offset:2048
    s_setprio 1
KM_OLD1:
    s_cmp_lg_u64 s[60:61], 0
    s_cbranch_scc1 KM_SLOW
    ds_read_b128 v[28:31], v16
    ds_read_b128 v[32:35], v16 offset:1024
    ds_read_b128 v[36:39], v17
    s_waitcnt lgkmcnt(2)
    v_mfma_f32_32x32x16_bf16 v[52:67], v[28:31], v[20:23], v[108:123]
    s_cmp_lt_u32 s36, 4
    s_cselect_b32 s72, 3, -1
    s_cselect_b32 s73, 0, 32768
    s_mov_b32 s54, 0
KM_LOOP:
    s_cmp_lg_u32 s54, s72
    s_cbranch_scc1 KM_NOSYNC
    s_barrier
KM_NOSYNC:
    s_cmp_lg_u32 s54, 13
    s_cbranch_scc1 KM_NP2
    s_setprio 0
KM_NP2:
    s_cmp_ge_u32 s68, s73
    s_cbranch_scc1 KM_NOPF
    buffer_load_dwordx4 v[124:127], v7, s[64:67], s68 offen offset:0
    buffer_load_dwordx4 v[124:127], v7, s[64:67], s68 offen offset:1024
    buffer_load_dwordx4 v[124:127], v7, s[64:67], s68 offen offset:2048
    s_add_u32 s68, s68, 3072
KM_NOPF:
    s_waitcnt lgkmcnt(0)
    v_mfma_f32_32x32x16_bf16 v[68:83], v[32:35], v[20:23], v[108:123]
    v_exp_f32 v52, v52
    v_exp_f32 v53, v53
    v_exp_f32 v54, v54
    v_exp_f32 v55, v55
    v_cvt_pk_bf16_f32 v84, v52, v53
    v_exp_f32 v56, v56
    v_exp_f32 v57, v57
    v_cvt_pk_bf16_f32 v85, v54, v55
    v_mfma_f32_32x32x16_bf16 v[92:107], v[48:51], v[88:91], v[92:107]
    ds_read_b128 v[28:31], v16 offset:2048
    ds_read_b128 v[40:43], v17 offset:1024
    ds_read_b128 v[44:47], v17 offset:512
    v_exp_f32 v58, v58
    v_exp_f32 v59, v59
    v_cvt_pk_bf16_f32 v86, v56, v57
    v_exp_f32 v60, v60
    v_exp_f32 v61, v61
    v_cvt_pk_bf16_f32 v87, v58, v59
    v_exp_f32 v62, v62
    v_exp_f32 v63, v63
    v_cvt_pk_bf16_f32 v88, v60, v61
    v_mfma_f32_32x32x16_bf16 v[92:107], v[36:39], v[84:87], v[92:107]
    v_exp_f32 v64, v64
    v_exp_f32 v65, v65
    v_cvt_pk_bf16_f32 v89, v62, v63
    v_exp_f32 v66, v66
    v_exp_f32 v67, v67
    v_cvt_pk_bf16_f32 v90, v64, v65
    v_cvt_pk_bf16_f32 v91, v66, v67
    s_waitcnt lgkmcnt(0)
    v_mfma_f32_32x32x16_bf16 v[52:67], v[28:31], v[20:23], v[108:123]
    v_exp_f32 v68, v68
    v_exp_f32 v69, v69
    v_exp_f32 v70, v70
    v_exp_f32 v71, v71
    v_cvt_pk_bf16_f32 v84, v68, v69
    v_exp_f32 v72, v72
    v_exp_f32 v73, v73
    v_cvt_pk_bf16_f32 v85, v70, v71
    v_mfma_f32_32x32x16_bf16 v[92:107], v[44:47], v[88:91], v[92:107]
    ds_read_b128 v[32:35], v16 offset:3072
    ds_read_b128 v[36:39], v17 offset:2048
    ds_read_b128 v[48:51], v17 offset:1536
    v_exp_f32 v74, v74
    v_exp_f32 v75, v75
    v_cvt_pk_bf16_f32 v86, v72, v73
    v_exp_f32 v76, v76
    v_exp_f32 v77, v77
    v_cvt_pk_bf16_f32 v87, v74, v75
    v_exp_f32 v78, v78
    v_exp_f32 v79, v79
    v_cvt_pk_bf16_f32 v88, v76, v77
    v_mfma_f32_32x32x16_bf16 v[92:107], v[40:43], v[84:87], v[92:107]
    v_exp_f32 v80, v80
    v_exp_f32 v81, v81
    v_cvt_pk_bf16_f32 v89, v78, v79
    v_exp_f32 v82, v82
    v_exp_f32 v83, v83
    v_cvt_pk_bf16_f32 v90, v80, v81
    v_cvt_pk_bf16_f32 v91, v82, v83
    s_waitcnt lgkmcnt(0)
    v_mfma_f32_32x32x16_bf16 v[68:83], v[32:35], v[20:23], v[108:123]
    v_exp_f32 v52, v52
    v_exp_f32 v53, v53
    v_exp_f32 v54, v54
    v_exp_f32 v55, v55
    v_cvt_pk_bf16_f32 v84, v52, v53
    v_exp_f32 v56, v56
    v_exp_f32 v57, v57
    v_cvt_pk_bf16_f32 v85, v54, v55
    v_mfma_f32_32x32x16_bf16 v[92:107], v[48:51], v[88:91], v[92:107]
    ds_read_b128 v[28:31], v16 offset:4096
    ds_read_b128 v[40:43], v17 offset:3072
    ds_read_b128 v[44:47], v17 offset:2560
    v_exp_f32 v58, v58
    v_exp_f32 v59, v59
    v_cvt_pk_bf16_f32 v86, v56, v57
    v_exp_f32 v60, v60
    v_exp_f32 v61, v61
    v_cvt_pk_bf16_f32 v87, v58, v59
    v_exp_f32 v62, v62
    v_exp_f32 v63, v63
    v_cvt_pk_bf16_f32 v88, v60, v61
    v_mfma_f32_32x32x16_bf16 v[92:107], v[36:39], v[84:87], v[92:107]
    v_exp_f32 v64, v64
    v_exp_f32 v65, v65
    v_cvt_pk_bf16_f32 v89, v62, v63
    v_exp_f32 v66, v66
    v_exp_f32 v67, v67
    v_cvt_pk_bf16_f32 v90, v64, v65
    v_cvt_pk_bf16_f32 v91, v66, v67
    s_waitcnt lgkmcnt(0)
    v_mfma_f32_32x32x16_bf16 v[52:67], v[28:31], v[20:23], v[108:123]
    v_exp_f32 v68, v68
    v_exp_f32 v69, v69
    v_exp_f32 v70, v70
    v_exp_f32 v71, v71
    v_cvt_pk_bf16_f32 v84, v68, v69
    v_exp_f32 v72, v72
    v_exp_f32 v73, v73
    v_cvt_pk_bf16_f32 v85, v70, v71
    v_mfma_f32_32x32x16_bf16 v[92:107], v[44:47], v[88:91], v[92:107]
    ds_read_b128 v[32:35], v16 offset:5120
    ds_read_b128 v[36:39], v17 offset:4096
    ds_read_b128 v[48:51], v17 offset:3584
    v_exp_f32 v74, v74
    v_exp_f32 v75, v75
    v_cvt_pk_bf16_f32 v86, v72, v73
    v_exp_f32 v76, v76
    v_exp_f32 v77, v77
    v_cvt_pk_bf16_f32 v87, v74, v75
    v_exp_f32 v78, v78
    v_exp_f32 v79, v79
    v_cvt_pk_bf16_f32 v88, v76, v77
    v_mfma_f32_32x32x16_bf16 v[92:107], v[40:43], v[84:87], v[92:107]
    v_exp_f32 v80, v80
    v_exp_f32 v81, v81
    v_cvt_pk_bf16_f32 v89, v78, v79
    v_exp_f32 v82, v82
    v_exp_f32 v83, v83
    v_cvt_pk_bf16_f32 v90, v80, v81
    v_cvt_pk_bf16_f32 v91, v82, v83
    v_add_u32 v16, 4096, v16
    v_add_u32 v17, v18, v17
    s_add_u32 s54, s54, 1
    s_cmp_lt_u32 s54, 16
    s_cbranch_scc1 KM_LOOP
    s_waitcnt lgkmcnt(0)
    v_mfma_f32_32x32x16_bf16 v[92:107], v[48:51], v[88:91], v[92:107]
    s_branch KM_FIN
KM_SLOW:
    s_cmp_ge_u32 s36, 4
    s_cbranch_scc1 KM_SLOW2
    s_barrier
KM_SLOW2:
    v_mov_b32 v108, 0xff61b1e6
    s_mov_b32 s54, 0
KM_SLOOP:
    ds_read_b128 v[28:31], v16
    ds_read_b128 v[36:39], v17
    ds_read_b128 v[44:47], v17 offset:512
    s_waitcnt lgkmcnt(0)
    v_mfma_f32_32x32x16_bf16 v[52:67], v[28:31], v[20:23], 0
    s_nop 11
    v_max_f32 v109, v52, v53
    v_max_f32 v109, v109, v54
    v_max_f32 v109, v109, v55
    v_max_f32 v109, v109, v56
    v_max_f32 v109, v109, v57
    v_max_f32 v109, v109, v58
    v_max_f32 v109, v109, v59
    v_max_f32 v109, v109, v60
    v_max_f32 v109, v109, v61
    v_max_f32 v109, v109, v62
    v_max_f32 v109, v109, v63
    v_max_f32 v109, v109, v64
    v_max_f32 v109, v109, v65
    v_max_f32 v109, v109, v66
    v_max_f32 v109, v109, v67
    v_mov_b32 v3, v109
    s_nop 1
    v_permlane32_swap_b32 v109, v3
    v_max_f32 v109, v109, v3
    v_max_f32 v109, v109, v108
    v_sub_f32 v110, v108, v109
    v_exp_f32 v110, v110
    v_mov_b32 v108, v109
    v_sub_f32 v52, v52, v109
    v_sub_f32 v53, v53, v109
    v_sub_f32 v54, v54, v109
    v_sub_f32 v55, v55, v109
    v_sub_f32 v56, v56, v109
    v_sub_f32 v57, v57, v109
    v_sub_f32 v58, v58, v109
    v_sub_f32 v59, v59, v109
    v_sub_f32 v60, v60, v109
    v_sub_f32 v61, v61, v109
    v_sub_f32 v62, v62, v109
    v_sub_f32 v63, v63, v109
    v_sub_f32 v64, v64, v109
    v_sub_f32 v65, v65, v109
    v_sub_f32 v66, v66, v109
    v_sub_f32 v67, v67, v109
    v_exp_f32 v52, v52
    v_exp_f32 v53, v53
    v_exp_f32 v54, v54
    v_exp_f32 v55, v55
    v_exp_f32 v56, v56
    v_exp_f32 v57, v57
    v_exp_f32 v58, v58
    v_exp_f32 v59, v59
    v_exp_f32 v60, v60
    v_exp_f32 v61, v61
    v_exp_f32 v62, v62
    v_exp_f32 v63, v63
    v_exp_f32 v64, v64
    v_exp_f32 v65, v65
    v_exp_f32 v66, v66
    v_exp_f32 v67, v67
    v_mul_f32 v92, v110, v92
    v_mul_f32 v93, v110, v93
    v_mul_f32 v94, v110, v94
    v_mul_f32 v95, v110, v95
    v_mul_f32 v96, v110, v96
    v_mul_f32 v97, v110, v97
    v_mul_f32 v98, v110, v98
    v_mul_f32 v99, v110, v99
    v_mul_f32 v100, v110, v100
    v_mul_f32 v101, v110, v101
    v_mul_f32 v102, v110, v102
    v_mul_f32 v103, v110, v103
    v_mul_f32 v104, v110, v104
    v_mul_f32 v105, v110, v105
    v_mul_f32 v106, v110, v106
    v_mul_f32 v107, v110, v107
    v_cvt_pk_bf16_f32 v84, v52, v53
    v_cvt_pk_bf16_f32 v85, v54, v55
    v_cvt_pk_bf16_f32 v86, v56, v57
    v_cvt_pk_bf16_f32 v87, v58, v59
    v_cvt_pk_bf16_f32 v88, v60, v61
    v_cvt_pk_bf16_f32 v89, v62, v63
    v_cvt_pk_bf16_f32 v90, v64, v65
    v_cvt_pk_bf16_f32 v91, v66, v67
    v_mfma_f32_32x32x16_bf16 v[92:107], v[36:39], v[84:87], v[92:107]
    s_nop 0
    v_mfma_f32_32x32x16_bf16 v[92:107], v[44:47], v[88:91], v[92:107]
    v_add_u32 v16, 1024, v16
    v_lshrrev_b32 v2, 2, v18
    v_add_u32 v17, v2, v17
    s_add_u32 s54, s54, 1
    s_cmp_lt_u32 s54, 64
    s_cbranch_scc1 KM_SLOOP
    s_mov_b32 s54, -1
KM_FIN:
    s_setprio 0
    s_nop 9
    v_mov_b32 v3, v100
    s_nop 1
    v_permlane32_swap_b32 v100, v3
    v_add_f32 v100, v100, v3
    v_rcp_f32 v2, v100
    s_nop 0
    v_mul_f32 v92, v2, v92
    v_mul_f32 v93, v2, v93
    v_mul_f32 v94, v2, v94
    v_mul_f32 v95, v2, v95
    v_mul_f32 v96, v2, v96
    v_mul_f32 v97, v2, v97
    v_mul_f32 v98, v2, v98
    v_mul_f32 v99, v2, v99
    v_cvt_pk_bf16_f32 v84, v92, v93
    v_cvt_pk_bf16_f32 v85, v94, v95
    v_cvt_pk_bf16_f32 v86, v96, v97
    v_cvt_pk_bf16_f32 v87, v98, v99
    s_lshl_b32 s40, s56, 15
    s_lshl_b32 s41, s50, 10
    s_add_u32 s40, s40, s41
    s_add_u32 s40, s40, 8388608
    buffer_store_dwordx4 v[84:87], v7, s[24:27], s40 offen sc1
    s_waitcnt vmcnt(0)
    s_barrier
    s_mov_b32 s57, s44
    s_mov_b32 s38, s48
    s_and_b32 s39, s49, 31
    s_and_b32 s43, s39, 3
    s_lshr_b32 s44, s39, 2
    s_lshl_b32 s50, s38, 2
    s_add_u32 s50, s50, s43
    s_mov_b32 s51, s44
    s_and_b32 s55, s36, 1
    s_bfe_u32 s54, s36, 0x10001
    s_lshr_b32 s56, s36, 2
    s_lshl_b32 s52, s38, 1
    s_and_b32 s40, s39, 1
    s_add_u32 s52, s52, s40
    s_lshr_b32 s53, s39, 1
    v_and_b32 v2, 15, v1
    v_lshrrev_b32 v3, 2, v2
    v_lshl_add_u32 v3, v5, 2, v3
    v_lshlrev_b32 v3, 6, v3
    v_and_b32 v2, 3, v2
    v_lshl_add_u32 v3, v2, 3, v3
    v_bfe_u32 v2, v1, 4, 1
    v_lshl_add_u32 v16, v2, 5, v3
    v_bfe_u32 v2, v1, 2, 3
    v_mul_u32_u24 v2, 1024, v2
    v_and_b32 v3, 3, v1
    v_lshl_add_u32 v2, v3, 4, v2
    v_lshrrev_b32 v3, 5, v1
    v_lshl_add_u32 v17, v3, 6, v2
    v_bfe_u32 v2, v1, 2, 3
    v_mul_u32_u24 v2, 3584, v2
    v_and_b32 v3, 3, v1
    v_lshl_add_u32 v2, v3, 4, v2
    v_lshrrev_b32 v3, 5, v1
    v_lshl_add_u32 v18, v3, 6, v2
    s_mov_b32 s60, s12
    s_and_b32 s61, s13, 0xffff
    s_mov_b32 s62, 1835008
    s_mov_b32 s63, 0x20000
    s_mov_b32 s64, s16
    s_and_b32 s65, s17, 0xffff
    s_mov_b32 s66, 1835008
    s_mov_b32 s67, 0x20000
    s_cmp_lt_u32 s36, 4
    s_cbranch_scc1 KM_NU_wo
    s_and_b32 s40, s37, 1
    s_lshl_b32 s40, s40, 2
    v_lshrrev_b32 v2, 4, v1
    v_or_b32 v2, s40, v2
    v_and_b32 v3, 7, v1
    v_xor_b32 v2, v2, v3
    v_lshlrev_b32 v2, 4, v2
    v_lshrrev_b32 v3, 3, v1
    v_lshlrev_b32 v3, 10, v3
    v_add_u32 v19, v2, v3
    s_mov_b32 s28, s8
    s_and_b32 s29, s9, 0xffff
    s_mov_b32 s30, 524288
    s_mov_b32 s31, 0x20000
    s_mov_b32 s32, s6
    s_and_b32 s33, s7, 0xffff
    s_mov_b32 s34, 2097152
    s_mov_b32 s35, 0x20000
    s_lshl_b32 s42, s37, 17
    s_lshl_b32 s40, s51, 7
    s_add_u32 s42, s42, s40
    s_lshl_b32 s41, s37, 14
    s_add_u32 m0, s41, 0
    s_add_u32 s40, s42, 0
    buffer_load_dwordx4 v17, s[28:31], s40 offen lds
    s_add_u32 m0, s41, 1024
    s_add_u32 s40, s42, 8192
    buffer_load_dwordx4 v17, s[28:31], s40 offen lds
    s_add_u32 m0, s41, 2048
    s_add_u32 s40, s42, 16384
    buffer_load_dwordx4 v17, s[28:31], s40 offen lds
    s_add_u32 m0, s41, 3072
    s_add_u32 s40, s42, 24576
    buffer_load_dwordx4 v17, s[28:31], s40 offen lds
    s_add_u32 m0, s41, 4096
    s_add_u32 s40, s42, 32768
    buffer_load_dwordx4 v17, s[28:31], s40 offen lds
    s_add_u32 m0, s41, 5120
    s_add_u32 s40, s42, 40960
    buffer_load_dwordx4 v17, s[28:31], s40 offen lds
    s_add_u32 m0, s41, 6144
    s_add_u32 s40, s42, 49152
    buffer_load_dwordx4 v17, s[28:31], s40 offen lds
    s_add_u32 m0, s41, 7168
    s_add_u32 s40, s42, 57344
    buffer_load_dwordx4 v17, s[28:31], s40 offen lds
    s_add_u32 m0, s41, 8192
    s_add_u32 s40, s42, 65536
    buffer_load_dwordx4 v17, s[28:31], s40 offen lds
    s_add_u32 m0, s41, 9216
    s_add_u32 s40, s42, 73728
    buffer_load_dwordx4 v17, s[28:31], s40 offen lds
    s_add_u32 m0, s41, 10240
    s_add_u32 s40, s42, 81920
    buffer_load_dwordx4 v17, s[28:31], s40 offen lds
    s_add_u32 m0, s41, 11264
    s_add_u32 s40, s42, 90112
    buffer_load_dwordx4 v17, s[28:31], s40 offen lds
    s_add_u32 m0, s41, 12288
    s_add_u32 s40, s42, 98304
    buffer_load_dwordx4 v17, s[28:31], s40 offen lds
    s_add_u32 m0, s41, 13312
    s_add_u32 s40, s42, 106496
    buffer_load_dwordx4 v17, s[28:31], s40 offen lds
    s_add_u32 m0, s41, 14336
    s_add_u32 s40, s42, 114688
    buffer_load_dwordx4 v17, s[28:31], s40 offen lds
    s_add_u32 m0, s41, 15360
    s_add_u32 s40, s42, 122880
    buffer_load_dwordx4 v17, s[28:31], s40 offen lds
    s_lshl_b32 s42, s50, 16
    s_lshl_b32 s40, s51, 7
    s_add_u32 s42, s42, s40
    s_lshl_b32 s40, s37, 13
    s_add_u32 s42, s42, s40
    s_lshl_b32 s41, s37, 10
    s_add_u32 m0, s41, 65536
    s_add_u32 s40, s42, 0
    buffer_load_dwordx4 v19, s[32:35], s40 offen lds
    s_add_u32 m0, s41, 69632
    s_add_u32 s40, s42, 32768
    buffer_load_dwordx4 v19, s[32:35], s40 offen lds
    s_mul_i32 s58, s37, 114688
    s_lshl_b32 s40, s53, 8
    s_add_u32 s58, s58, s40
    s_mul_i32 s59, s37, 458752
    s_lshl_b32 s40, s51, 7
    s_add_u32 s59, s59, s40
    s_waitcnt vmcnt(0)
KM_NU_wo:
    s_lshr_b32 s70, s36, 1
    s_lshl_b32 s40, s70, 14
    v_add_u32 v100, s40, v16
    s_lshl_b32 s42, s50, 16
    s_lshl_b32 s40, s55, 15
    s_add_u32 s42, s42, s40
    s_lshl_b32 s40, s70, 13
    s_add_u32 s42, s42, s40
    s_add_u32 s42, s42, 8388608
    s_add_u32 s71, s42, 4096
    s_cmp_lg_u32 s36, 0
    s_cbranch_scc1 KM_NW0_2
    s_mov_b32 s45, s57
    s_lshl_b32 s45, s45, 8
    s_add_u32 s45, s45, 22020096
    v_mov_b32 v2, 1
    v_mov_b32 v3, 0
    s_mov_b64 exec, 1
    buffer_atomic_add v2, v3, s[24:27], s45 offen sc1
    s_mov_b64 exec, -1
    s_mov_b32 s45, s38
    s_lshl_b32 s45, s45, 8
    s_add_u32 s45, s45, 22020096
    v_mov_b32 v3, 0
    s_mov_b32 s41, 3000000
KM_POLL_2:
    buffer_load_dword v2, v3, s[24:27], s45 offen sc1
    s_waitcnt vmcnt(0)
    v_readfirstlane_b32 s40, v2
    s_nop 0
    s_cmp_ge_u32 s40, 32
    s_cbranch_scc1 KM_PD_2
    s_sleep 1
    s_sub_u32 s41, s41, 1
    s_cmp_lg_u32 s41, 0
    s_cbranch_scc1 KM_POLL_2
KM_PD_2:
KM_NW0_2:
    s_barrier
    buffer_load_dwordx4 v[20:23], v7, s[24:27], s42 offen offset:0 sc1
    buffer_load_dwordx4 v[24:27], v7, s[24:27], s42 offen offset:1024 sc1
    buffer_load_dwordx4 v[28:31], v7, s[24:27], s42 offen offset:2048 sc1
    buffer_load_dwordx4 v[32:35], v7, s[24:27], s42 offen offset:3072 sc1
    buffer_load_dwordx4 v[36:39], v7, s[24:27], s71 offen offset:0 sc1
    buffer_load_dwordx4 v[40:43], v7, s[24:27], s71 offen offset:1024 sc1
    buffer_load_dwordx4 v[44:47], v7, s[24:27], s71 offen offset:2048 sc1
    buffer_load_dwordx4 v[48:51], v7, s[24:27], s71 offen offset:3072 sc1
    ds_read_b64_tr_b16 v[84:85], v100 offset:0
    ds_read_b64_tr_b16 v[86:87], v100 offset:1024
    ds_read_b64_tr_b16 v[88:89], v100 offset:512
    ds_read_b64_tr_b16 v[90:91], v100 offset:1536
    v_lshrrev_b32 v4, 1, v6
    v_and_b32 v4, 7, v4
    s_lshl_b32 s40, s55, 12
    s_add_u32 s40, s40, 65536
    v_lshlrev_b32 v3, 7, v6
    v_lshl_add_u32 v3, v5, 3, v3
    v_add_u32 v3, s40, v3
    s_lshl_b32 s41, s54, 2
    s_lshl_b32 s40, s56, 1
    s_add_u32 s41, s41, s40
    s_add_u32 s40, s41, 0
    v_xor_b32 v2, s40, v4
    v_lshl_add_u32 v2, v2, 4, v3
    ds_read_b64 v[104:105], v2
    s_add_u32 s40, s41, 1
    v_xor_b32 v2, s40, v4
    v_lshl_add_u32 v2, v2, 4, v3
    ds_read_b64 v[106:107], v2
    ds_read_b64_tr_b16 v[92:93], v100 offset:2048
    ds_read_b64_tr_b16 v[94:95], v100 offset:3072
    ds_read_b64_tr_b16 v[96:97], v100 offset:2560
    ds_read_b64_tr_b16 v[98:99], v100 offset:3584
    s_waitcnt lgkmcnt(4)
    s_waitcnt vmcnt(7)
    v_mfma_f32_32x32x16_bf16 v[52:67], v[84:87], v[20:23], 0
    v_mfma_f32_32x32x16_bf16 v[68:83], v[88:91], v[20:23], 0
    ds_read_b64_tr_b16 v[84:85], v100 offset:4096
    ds_read_b64_tr_b16 v[86:87], v100 offset:5120
    ds_read_b64_tr_b16 v[88:89], v100 offset:4608
    ds_read_b64_tr_b16 v[90:91], v100 offset:5632
    s_waitcnt lgkmcnt(4)
    s_waitcnt vmcnt(6)
    v_mfma_f32_32x32x16_bf16 v[52:67], v[92:95], v[24:27], v[52:67]
    v_mfma_f32_32x32x16_bf16 v[68:83], v[96:99], v[24:27], v[68:83]
    ds_read_b64_tr_b16 v[92:93], v100 offset:6144
    ds_read_b64_tr_b16 v[94:95], v100 offset:7168
    ds_read_b64_tr_b16 v[96:97], v100 offset:6656
    ds_read_b64_tr_b16 v[98:99], v100 offset:7680
    s_waitcnt lgkmcnt(4)
    s_waitcnt vmcnt(5)
    v_mfma_f32_32x32x16_bf16 v[52:67], v[84:87], v[28:31], v[52:67]
    v_mfma_f32_32x32x16_bf16 v[68:83], v[88:91], v[28:31], v[68:83]
    ds_read_b64_tr_b16 v[84:85], v100 offset:8192
    ds_read_b64_tr_b16 v[86:87], v100 offset:9216
    ds_read_b64_tr_b16 v[88:89], v100 offset:8704
    ds_read_b64_tr_b16 v[90:91], v100 offset:9728
    s_waitcnt lgkmcnt(4)
    s_waitcnt vmcnt(4)
    v_mfma_f32_32x32x16_bf16 v[52:67], v[92:95], v[32:35], v[52:67]
    v_mfma_f32_32x32x16_bf16 v[68:83], v[96:99], v[32:35], v[68:83]
    ds_read_b64_tr_b16 v[92:93], v100 offset:10240
    ds_read_b64_tr_b16 v[94:95], v100 offset:11264
    ds_read_b64_tr_b16 v[96:97], v100 offset:10752
    ds_read_b64_tr_b16 v[98:99], v100 offset:11776
    s_waitcnt lgkmcnt(4)
    s_waitcnt vmcnt(3)
    v_mfma_f32_32x32x16_bf16 v[52:67], v[84:87], v[36:39], v[52:67]
    v_mfma_f32_32x32x16_bf16 v[68:83], v[88:91], v[36:39], v[68:83]
    ds_read_b64_tr_b16 v[84:85], v100 offset:12288
    ds_read_b64_tr_b16 v[86:87], v100 offset:13312
    ds_read_b64_tr_b16 v[88:89], v100 offset:12800
    ds_read_b64_tr_b16 v[90:91], v100 offset:13824
    s_waitcnt lgkmcnt(4)
    s_waitcnt vmcnt(2)
    v_mfma_f32_32x32x16_bf16 v[52:67], v[92:95], v[40:43], v[52:67]
    v_mfma_f32_32x32x16_bf16 v[68:83], v[96:99], v[40:43], v[68:83]
    ds_read_b64_tr_b16 v[92:93], v100 offset:14336
    ds_read_b64_tr_b16 v[94:95], v100 offset:15360
    ds_read_b64_tr_b16 v[96:97], v100 offset:14848
    ds_read_b64_tr_b16 v[98:99], v100 offset:15872
    s_waitcnt lgkmcnt(4)
    s_waitcnt vmcnt(1)
    v_mfma_f32_32x32x16_bf16 v[52:67], v[84:87], v[44:47], v[52:67]
    v_mfma_f32_32x32x16_bf16 v[68:83], v[88:91], v[44:47], v[68:83]
    s_waitcnt lgkmcnt(0)
    s_waitcnt vmcnt(0)
    v_mfma_f32_32x32x16_bf16 v[52:67], v[92:95], v[48:51], v[52:67]
    v_mfma_f32_32x32x16_bf16 v[68:83], v[96:99], v[48:51], v[68:83]
    s_lshl_b32 s40, s55, 14
    s_lshl_b32 s41, s70, 12
    s_add_u32 s40, s40, s41
    s_add_u32 s40, s40, 73728
    v_add_u32 v2, s40, v7
    s_nop 5
    ds_write_b128 v2, v[52:55] offset:0
    ds_write_b128 v2, v[56:59] offset:1024
    ds_write_b128 v2, v[60:63] offset:2048
    ds_write_b128 v2, v[64:67] offset:3072
    ds_write_b128 v2, v[68:71] offset:32768
    ds_write_b128 v2, v[72:75] offset:33792
    ds_write_b128 v2, v[76:79] offset:34816
    ds_write_b128 v2, v[80:83] offset:35840
    s_waitcnt lgkmcnt(0)
    s_barrier
    s_lshl_b32 s40, s37, 14
    s_lshl_b32 s41, s56, 11
    s_add_u32 s40, s40, s41
    s_add_u32 s40, s40, 73728
    v_add_u32 v2, s40, v7
    ds_read_b128 v[20:23], v2 offset:0
    ds_read_b128 v[24:27], v2 offset:1024
    ds_read_b128 v[28:31], v2 offset:4096
    ds_read_b128 v[32:35], v2 offset:5120
    ds_read_b128 v[36:39], v2 offset:8192
    ds_read_b128 v[40:43], v2 offset:9216
    ds_read_b128 v[44:47], v2 offset:12288
    ds_read_b128 v[48:51], v2 offset:13312
    s_waitcnt lgkmcnt(4)
    v_add_f32 v20, v20, v28
    v_add_f32 v21, v21, v29
    v_add_f32 v22, v22, v30
    v_add_f32 v23, v23, v31
    v_add_f32 v24, v24, v32
    v_add_f32 v25, v25, v33
    v_add_f32 v26, v26, v34
    v_add_f32 v27, v27, v35
    s_waitcnt lgkmcnt(0)
    v_add_f32 v36, v36, v44
    v_add_f32 v37, v37, v45
    v_add_f32 v38, v38, v46
    v_add_f32 v39, v39, v47
    v_add_f32 v40, v40, v48
    v_add_f32 v41, v41, v49
    v_add_f32 v42, v42, v50
    v_add_f32 v43, v43, v51
    v_add_f32 v20, v20, v36
    v_add_f32 v21, v21, v37
    v_add_f32 v22, v22, v38
    v_add_f32 v23, v23, v39
    v_add_f32 v24, v24, v40
    v_add_f32 v25, v25, v41
    v_add_f32 v26, v26, v42
    v_add_f32 v27, v27, v43
    v_lshlrev_b32 v52, 16, v104
    v_and_b32 v53, 0xffff0000, v104
    v_lshlrev_b32 v54, 16, v105
    v_and_b32 v55, 0xffff0000, v105
    v_lshlrev_b32 v56, 16, v106
    v_and_b32 v57, 0xffff0000, v106
    v_lshlrev_b32 v58, 16, v107
    v_and_b32 v59, 0xffff0000, v107
    v_add_f32 v20, v20, v52
    v_add_f32 v21, v21, v53
    v_add_f32 v22, v22, v54
    v_add_f32 v23, v23, v55
    v_add_f32 v24, v24, v56
    v_add_f32 v25, v25, v57
    v_add_f32 v26, v26, v58
    v_add_f32 v27, v27, v59
    v_cvt_pk_bf16_f32 v8, v20, v21
    v_cvt_pk_bf16_f32 v9, v22, v23
    v_cvt_pk_bf16_f32 v10, v24, v25
    v_cvt_pk_bf16_f32 v11, v26, v27
    s_lshl_b32 s72, s50, 1
    s_add_u32 s72, s72, s55
    s_lshl_b32 s73, s51, 2
    s_lshl_b32 s40, s54, 1
    s_add_u32 s73, s73, s40
    s_add_u32 s73, s73, s56
    s_lshl_b32 s42, s72, 15
    s_lshl_b32 s40, s73, 10
    s_add_u32 s42, s42, s40
    s_add_u32 s42, s42, 10485760
    buffer_store_dwordx4 v[8:11], v7, s[24:27], s42 offen sc1
    v_lshlrev_b32 v52, 16, v8
    v_and_b32 v53, 0xffff0000, v8
    v_lshlrev_b32 v54, 16, v9
    v_and_b32 v55, 0xffff0000, v9
    v_lshlrev_b32 v56, 16, v10
    v_and_b32 v57, 0xffff0000, v10
    v_lshlrev_b32 v58, 16, v11
    v_and_b32 v59, 0xffff0000, v11
    v_add_f32 v68, v52, v53
    v_mul_f32 v69, v52, v52
    v_fmac_f32 v69, v53, v53
    v_add_f32 v68, v68, v54
    v_fmac_f32 v69, v54, v54
    v_add_f32 v68, v68, v55
    v_fmac_f32 v69, v55, v55
    v_add_f32 v68, v68, v56
    v_fmac_f32 v69, v56, v56
    v_add_f32 v68, v68, v57
    v_fmac_f32 v69, v57, v57
    v_add_f32 v68, v68, v58
    v_fmac_f32 v69, v58, v58
    v_add_f32 v68, v68, v59
    v_fmac_f32 v69, v59, v59
    v_mov_b32 v3, v68
    s_nop 1
    v_permlane32_swap_b32 v68, v3
    v_add_f32 v68, v68, v3
    v_mov_b32 v4, v69
    s_nop 1
    v_permlane32_swap_b32 v69, v4
    v_add_f32 v69, v69, v4
    s_lshl_b32 s40, s36, 8
    s_add_u32 s40, s40, 140288
    v_lshl_add_u32 v2, v6, 3, s40
    ds_write_b64 v2, v[68:69]
    s_waitcnt lgkmcnt(0)
    s_barrier
    s_cmp_ge_u32 s36, 2
    s_cbranch_scc1 KM_NHS
    ds_read_b64 v[68:69], v2 offset:0
    ds_read_b64 v[70:71], v2 offset:512
    ds_read_b64 v[72:73], v2 offset:1024
    ds_read_b64 v[74:75], v2 offset:1536
    s_waitcnt lgkmcnt(0)
    v_add_f32 v68, v68, v70
    v_add_f32 v72, v72, v74
    v_add_f32 v69, v69, v71
    v_add_f32 v73, v73, v75
    v_add_f32 v68, v68, v72
    v_add_f32 v69, v69, v73
    s_lshl_b32 s40, s72, 11
    s_lshl_b32 s41, s51, 8
    s_add_u32 s40, s40, s41
    s_add_u32 s40, s40, 20971520
    v_lshlrev_b32 v2, 3, v6
    s_mov_b32 exec_hi, 0
    buffer_store_dwordx2 v[68:69], v2, s[24:27], s40 offen sc1
    s_mov_b64 exec, -1
KM_NHS:
    s_cmp_ge_u32 s39, 28
    s_cbranch_scc1 KM_NW1A
    s_lshl_b32 s41, s36, 13
    s_mul_i32 s42, s36, 229376
    s_lshl_b32 s40, s53, 8
    s_add_u32 s42, s42, s40
    s_add_u32 m0, s41, 0
    s_add_u32 s40, s42, 0
    buffer_load_dwordx4 v18, s[60:63], s40 offen lds
    s_add_u32 m0, s41, 1024
    s_add_u32 s40, s42, 28672
    buffer_load_dwordx4 v18, s[60:63], s40 offen lds
    s_add_u32 m0, s41, 2048
    s_add_u32 s40, s42, 57344
    buffer_load_dwordx4 v18, s[60:63], s40 offen lds
    s_add_u32 m0, s41, 3072
    s_add_u32 s40, s42, 86016
    buffer_load_dwordx4 v18, s[60:63], s40 offen lds
    s_add_u32 m0, s41, 4096
    s_add_u32 s40, s42, 114688
    buffer_load_dwordx4 v18, s[60:63], s40 offen lds
    s_add_u32 m0, s41, 5120
    s_add_u32 s40, s42, 143360
    buffer_load_dwordx4 v18, s[60:63], s40 offen lds
    s_add_u32 m0, s41, 6144
    s_add_u32 s40, s42, 172032
    buffer_load_dwordx4 v18, s[60:63], s40 offen lds
    s_add_u32 m0, s41, 7168
    s_add_u32 s40, s42, 200704
    buffer_load_dwordx4 v18, s[60:63], s40 offen lds
    s_waitcnt vmcnt(8) lgkmcnt(0)
    s_branch KM_NW1B
KM_NW1A:
    s_lshr_b32 s41, s36, 2
    s_mul_i32 s42, s41, 458752
    s_lshl_b32 s40, s51, 7
    s_add_u32 s42, s42, s40
    s_lshl_b32 s40, s37, 16
    s_add_u32 s42, s42, s40
    s_lshl_b32 s41, s36, 13
    s_add_u32 m0, s41, 0
    s_add_u32 s40, s42, 0
    buffer_load_dwordx4 v17, s[64:67], s40 offen lds
    s_add_u32 m0, s41, 1024
    s_add_u32 s40, s42, 8192
    buffer_load_dwordx4 v17, s[64:67], s40 offen lds
    s_add_u32 m0, s41, 2048
    s_add_u32 s40, s42, 16384
    buffer_load_dwordx4 v17, s[64:67], s40 offen lds
    s_add_u32 m0, s41, 3072
    s_add_u32 s40, s42, 24576
    buffer_load_dwordx4 v17, s[64:67], s40 offen lds
    s_add_u32 m0, s41, 4096
    s_add_u32 s40, s42, 32768
    buffer_load_dwordx4 v17, s[64:67], s40 offen lds
    s_add_u32 m0, s41, 5120
    s_add_u32 s40, s42, 40960
    buffer_load_dwordx4 v17, s[64:67], s40 offen lds
    s_add_u32 m0, s41, 6144
    s_add_u32 s40, s42, 49152
    buffer_load_dwordx4 v17, s[64:67], s40 offen lds
    s_add_u32 m0, s41, 7168
    s_add_u32 s40, s42, 57344
    buffer_load_dwordx4 v17, s[64:67], s40 offen lds
    s_waitcnt vmcnt(8) lgkmcnt(0)
KM_NW1B:
    s_barrier
    s_cmp_lg_u32 s36, 0
    s_cbranch_scc1 KM_NW0_3s
    s_lshl_b32 s45, s38, 1
    s_lshr_b32 s40, s43, 1
    s_add_u32 s45, s45, s40
    s_lshl_b32 s45, s45, 8
    s_add_u32 s45, s45, 22022144
    v_mov_b32 v2, 1
    v_mov_b32 v3, 0
    s_mov_b64 exec, 1
    buffer_atomic_add v2, v3, s[24:27], s45 offen sc1
    s_mov_b64 exec, -1
KM_NW0_3s:
    s_cmp_ge_u32 s39, 28
    s_cbranch_scc1 KM_NOP4
    s_cmp_lt_u32 s36, 4
    s_cbranch_scc1 KM_NU_w1
    s_lshl_b32 s41, s37, 12
    s_add_u32 m0, s41, 65536
    s_add_u32 s40, s58, 128
    buffer_load_dwordx4 v18, s[60:63], s40 offen lds
    s_add_u32 m0, s41, 66560
    s_add_u32 s40, s58, 28800
    buffer_load_dwordx4 v18, s[60:63], s40 offen lds
    s_add_u32 m0, s41, 67584
    s_add_u32 s40, s58, 57472
    buffer_load_dwordx4 v18, s[60:63], s40 offen lds
    s_add_u32 m0, s41, 68608
    s_add_u32 s40, s58, 86144
    buffer_load_dwordx4 v18, s[60:63], s40 offen lds
    s_add_u32 m0, s41, 81920
    s_add_u32 s40, s58, 458880
    buffer_load_dwordx4 v18, s[60:63], s40 offen lds
    s_add_u32 m0, s41, 82944
    s_add_u32 s40, s58, 487552
    buffer_load_dwordx4 v18, s[60:63], s40 offen lds
    s_add_u32 m0, s41, 83968
    s_add_u32 s40, s58, 516224
    buffer_load_dwordx4 v18, s[60:63], s40 offen lds
    s_add_u32 m0, s41, 84992
    s_add_u32 s40, s58, 544896
    buffer_load_dwordx4 v18, s[60:63], s40 offen lds
    s_add_u32 m0, s41, 98304
    s_add_u32 s40, s58, 917632
    buffer_load_dwordx4 v18, s[60:63], s40 offen lds
    s_add_u32 m0, s41, 99328
    s_add_u32 s40, s58, 946304
    buffer_load_dwordx4 v18, s[60:63], s40 offen lds
    s_add_u32 m0, s41, 100352
    s_add_u32 s40, s58, 974976
    buffer_load_dwordx4 v18, s[60:63], s40 offen lds
    s_add_u32 m0, s41, 101376
    s_add_u32 s40, s58, 1003648
    buffer_load_dwordx4 v18, s[60:63], s40 offen lds
    s_add_u32 m0, s41, 114688
    s_add_u32 s40, s58, 1376384
    buffer_load_dwordx4 v18, s[60:63], s40 offen lds
    s_add_u32 m0, s41, 115712
    s_add_u32 s40, s58, 1405056
    buffer_load_dwordx4 v18, s[60:63], s40 offen lds
    s_add_u32 m0, s41, 116736
    s_add_u32 s40, s58, 1433728
    buffer_load_dwordx4 v18, s[60:63], s40 offen lds
    s_add_u32 m0, s41, 117760
    s_add_u32 s40, s58, 1462400
    buffer_load_dwordx4 v18, s[60:63], s40 offen lds
KM_NU_w1:
    s_mov_b32 s28, s14
    s_and_b32 s29, s15, 0xffff
    s_mov_b32 s30, 3584
    s_mov_b32 s31, 0x20000
    s_lshl_b32 s74, s52, 2
    s_add_u32 s74, s74, s37
    v_lshlrev_b32 v3, 2, v1
    s_lshl_b32 s41, s53, 8
    buffer_load_dword v204, v3, s[28:31], s41 offen
    s_xor_b32 s75, s37, 0
    s_lshl_b32 s75, s75, 10
    s_xor_b32 s76, s37, 1
    s_lshl_b32 s76, s76, 10
    s_xor_b32 s77, s37, 2
    s_lshl_b32 s77, s77, 10
    s_xor_b32 s78, s37, 3
    s_lshl_b32 s78, s78, 10
    s_lshl_b32 s41, s56, 15
    s_lshl_b32 s40, s75, 1
    s_add_u32 s40, s40, s41
    v_add_u32 v188, s40, v16
    v_add_u32 v192, 65536, v188
    s_lshl_b32 s40, s76, 1
    s_add_u32 s40, s40, s41
    v_add_u32 v189, s40, v16
    v_add_u32 v193, 65536, v189
    s_lshl_b32 s40, s77, 1
    s_add_u32 s40, s40, s41
    v_add_u32 v190, s40, v16
    v_add_u32 v194, 65536, v190
    s_lshl_b32 s40, s78, 1
    s_add_u32 s40, s40, s41
    v_add_u32 v191, s40, v16
    v_add_u32 v195, 65536, v191
    s_cmp_lt_u32 s36, 2
    s_cbranch_scc1 KM_NCS
    s_cmp_ge_u32 s36, 4
    s_cbranch_scc1 KM_NCS
    s_and_b32 s40, s36, 1
    s_lshl_b32 s40, s40, 8
    v_lshlrev_b32 v3, 2, v1
    v_add_u32 v3, s40, v3
    s_lshl_b32 s40, s53, 9
    s_add_u32 s40, s40, 21495808
    buffer_load_dword v196, v3, s[24:27], s40 offen
    s_add_u32 s40, s40, 7168
    buffer_load_dword v197, v3, s[24:27], s40 offen
    s_add_u32 s40, s40, 7168
    buffer_load_dword v198, v3, s[24:27], s40 offen
    s_add_u32 s40, s40, 7168
    buffer_load_dword v199, v3, s[24:27], s40 offen
    s_add_u32 s40, s40, 7168
    buffer_load_dword v200, v3, s[24:27], s40 offen
    s_add_u32 s40, s40, 7168
    buffer_load_dword v201, v3, s[24:27], s40 offen
    s_add_u32 s40, s40, 7168
    buffer_load_dword v202, v3, s[24:27], s40 offen
    s_add_u32 s40, s40, 7168
    buffer_load_dword v203, v3, s[24:27], s40 offen
    s_waitcnt vmcnt(0)
    v_add_f32 v196, v196, v200
    v_add_f32 v197, v197, v201
    v_add_f32 v198, v198, v202
    v_add_f32 v199, v199, v203
    v_add_f32 v196, v196, v198
    v_add_f32 v197, v197, v199
    v_add_f32 v196, v196, v197
    v_add_u32 v3, 139264, v3
    ds_write_b32 v3, v196
KM_NCS:
    s_waitcnt vmcnt(0)
    v_lshlrev_b32 v198, 16, v204
    v_and_b32 v199, 0xffff0000, v204
    v_lshlrev_b32 v2, 3, v1
    v_add_u32 v2, 139776, v2
    ds_write_b64 v2, v[198:199]
    s_lshl_b32 s42, s74, 15
    s_lshl_b32 s40, s56, 14
    s_add_u32 s42, s42, s40
    s_add_u32 s42, s42, 10485760
    s_lshl_b32 s79, s74, 11
    s_add_u32 s79, s79, 20971520
    v_lshlrev_b32 v4, 3, v6
    v_lshl_add_u32 v4, v5, 10, v4
    s_add_u32 s75, s75, s42
    s_add_u32 s76, s76, s42
    s_add_u32 s77, s77, s42
    s_add_u32 s78, s78, s42
    s_waitcnt vmcnt(0) lgkmcnt(0)
    s_cmp_lg_u32 s36, 0
    s_cbranch_scc1 KM_NW0_3
    s_mov_b32 s45, s52
    s_lshl_b32 s45, s45, 8
    s_add_u32 s45, s45, 22022144
    v_mov_b32 v3, 0
    s_mov_b32 s41, 3000000
KM_POLL_3:
    buffer_load_dword v2, v3, s[24:27], s45 offen sc1
    s_waitcnt vmcnt(0)
    v_readfirstlane_b32 s40, v2
    s_nop 0
    s_cmp_ge_u32 s40, 16
    s_cbranch_scc1 KM_PD_3
    s_sleep 1
    s_sub_u32 s41, s41, 1
    s_cmp_lg_u32 s41, 0
    s_cbranch_scc1 KM_POLL_3
KM_PD_3:
KM_NW0_3:
    s_barrier
    buffer_load_dwordx4 v[20:23], v7, s[24:27], s75 offen sc1
    buffer_load_dwordx4 v[24:27], v7, s[24:27], s76 offen sc1
    buffer_load_dwordx4 v[28:31], v7, s[24:27], s77 offen sc1
    buffer_load_dwordx4 v[32:35], v7, s[24:27], s78 offen sc1
    buffer_load_dwordx2 v[196:197], v4, s[24:27], s79 offen offset:0 sc1
    buffer_load_dwordx2 v[198:199], v4, s[24:27], s79 offen offset:256 sc1
    buffer_load_dwordx2 v[200:201], v4, s[24:27], s79 offen offset:512 sc1
    buffer_load_dwordx2 v[202:203], v4, s[24:27], s79 offen offset:768 sc1
    s_add_u32 s75, s75, 4096
    buffer_load_dwordx4 v[36:39], v7, s[24:27], s75 offen sc1
    s_add_u32 s76, s76, 4096
    buffer_load_dwordx4 v[40:43], v7, s[24:27], s76 offen sc1
    s_add_u32 s77, s77, 4096
    buffer_load_dwordx4 v[44:47], v7, s[24:27], s77 offen sc1
    s_add_u32 s78, s78, 4096
    buffer_load_dwordx4 v[48:51], v7, s[24:27], s78 offen sc1
    ds_read_b64_tr_b16 v[148:149], v188 offset:0
    ds_read_b64_tr_b16 v[150:151], v188 offset:1024
    ds_read_b64_tr_b16 v[152:153], v188 offset:512
    ds_read_b64_tr_b16 v[154:155], v188 offset:1536
    ds_read_b64_tr_b16 v[156:157], v192 offset:0
    ds_read_b64_tr_b16 v[158:159], v192 offset:1024
    ds_read_b64_tr_b16 v[160:161], v192 offset:512
    ds_read_b64_tr_b16 v[162:163], v192 offset:1536
    ds_read_b64_tr_b16 v[164:165], v189 offset:0
    ds_read_b64_tr_b16 v[166:167], v189 offset:1024
    ds_read_b64_tr_b16 v[168:169], v189 offset:512
    ds_read_b64_tr_b16 v[170:171], v189 offset:1536
    ds_read_b64_tr_b16 v[172:173], v193 offset:0
    ds_read_b64_tr_b16 v[174:175], v193 offset:1024
    ds_read_b64_tr_b16 v[176:177], v193 offset:512
    ds_read_b64_tr_b16 v[178:179], v193 offset:1536
    s_waitcnt lgkmcnt(8)
    s_waitcnt vmcnt(8)
    v_mfma_f32_32x32x16_bf16 v[84:99], v[148:151], v[20:23], 0
    v_mfma_f32_32x32x16_bf16 v[100:115], v[152:155], v[20:23], 0
    v_mfma_f32_32x32x16_bf16 v[116:131], v[156:159], v[20:23], 0
    v_mfma_f32_32x32x16_bf16 v[132:147], v[160:163], v[20:23], 0
    s_add_u32 s75, s75, 4096
    buffer_load_dwordx4 v[52:55], v7, s[24:27], s75 offen sc1
    s_add_u32 s76, s76, 4096
    buffer_load_dwordx4 v[56:59], v7, s[24:27], s76 offen sc1
    s_add_u32 s77, s77, 4096
    buffer_load_dwordx4 v[60:63], v7, s[24:27], s77 offen sc1
    s_add_u32 s78, s78, 4096
    buffer_load_dwordx4 v[64:67], v7, s[24:27], s78 offen sc1
    ds_read_b64_tr_b16 v[148:149], v190 offset:0
    ds_read_b64_tr_b16 v[150:151], v190 offset:1024
    ds_read_b64_tr_b16 v[152:153], v190 offset:512
    ds_read_b64_tr_b16 v[154:155], v190 offset:1536
    ds_read_b64_tr_b16 v[156:157], v194 offset:0
    ds_read_b64_tr_b16 v[158:159], v194 offset:1024
    ds_read_b64_tr_b16 v[160:161], v194 offset:512
    ds_read_b64_tr_b16 v[162:163], v194 offset:1536
    s_waitcnt lgkmcnt(8)
    v_mfma_f32_32x32x16_bf16 v[84:99], v[164:167], v[24:27], v[84:99]
    v_mfma_f32_32x32x16_bf16 v[100:115], v[168:171], v[24:27], v[100:115]
    v_mfma_f32_32x32x16_bf16 v[116:131], v[172:175], v[24:27], v[116:131]
    v_mfma_f32_32x32x16_bf16 v[132:147], v[176:179], v[24:27], v[132:147]
    s_add_u32 s75, s75, 4096
    buffer_load_dwordx4 v[68:71], v7, s[24:27], s75 offen sc1
    s_add_u32 s76, s76, 4096
    buffer_load_dwordx4 v[72:75], v7, s[24:27], s76 offen sc1
    s_add_u32 s77, s77, 4096
    buffer_load_dwordx4 v[76:79], v7, s[24:27], s77 offen sc1
    s_add_u32 s78, s78, 4096
    buffer_load_dwordx4 v[80:83], v7, s[24:27], s78 offen sc1
    ds_read_b64_tr_b16 v[164:165], v191 offset:0
    ds_read_b64_tr_b16 v[166:167], v191 offset:1024
    ds_read_b64_tr_b16 v[168:169], v191 offset:512
    ds_read_b64_tr_b16 v[170:171], v191 offset:1536
    ds_read_b64_tr_b16 v[172:173], v195 offset:0
    ds_read_b64_tr_b16 v[174:175], v195 offset:1024
    ds_read_b64_tr_b16 v[176:177], v195 offset:512
    ds_read_b64_tr_b16 v[178:179], v195 offset:1536
    s_waitcnt lgkmcnt(8)
    v_mfma_f32_32x32x16_bf16 v[84:99], v[148:151], v[28:31], v[84:99]
    v_mfma_f32_32x32x16_bf16 v[100:115], v[152:155], v[28:31], v[100:115]
    v_mfma_f32_32x32x16_bf16 v[116:131], v[156:159], v[28:31], v[116:131]
    v_mfma_f32_32x32x16_bf16 v[132:147], v[160:163], v[28:31], v[132:147]
    ds_read_b64_tr_b16 v[148:149], v188 offset:8192
    ds_read_b64_tr_b16 v[150:151], v188 offset:9216
    ds_read_b64_tr_b16 v[152:153], v188 offset:8704
    ds_read_b64_tr_b16 v[154:155], v188 offset:9728
    ds_read_b64_tr_b16 v[156:157], v192 offset:8192
    ds_read_b64_tr_b16 v[158:159], v192 offset:9216
    ds_read_b64_tr_b16 v[160:161], v192 offset:8704
    ds_read_b64_tr_b16 v[162:163], v192 offset:9728
    s_waitcnt lgkmcnt(8)
    v_mfma_f32_32x32x16_bf16 v[84:99], v[164:167], v[32:35], v[84:99]
    v_mfma_f32_32x32x16_bf16 v[100:115], v[168:171], v[32:35], v[100:115]
    v_mfma_f32_32x32x16_bf16 v[116:131], v[172:175], v[32:35], v[116:131]
    v_mfma_f32_32x32x16_bf16 v[132:147], v[176:179], v[32:35], v[132:147]
    ds_read_b64_tr_b16 v[164:165], v189 offset:8192
    ds_read_b64_tr_b16 v[166:167], v189 offset:9216
    ds_read_b64_tr_b16 v[168:169], v189 offset:8704
    ds_read_b64_tr_b16 v[170:171], v189 offset:9728
    ds_read_b64_tr_b16 v[172:173], v193 offset:8192
    ds_read_b64_tr_b16 v[174:175], v193 offset:9216
    ds_read_b64_tr_b16 v[176:177], v193 offset:8704
    ds_read_b64_tr_b16 v[178:179], v193 offset:9728
    s_waitcnt lgkmcnt(8)
    s_waitcnt vmcnt(8)
    v_mfma_f32_32x32x16_bf16 v[84:99], v[148:151], v[36:39], v[84:99]
    v_mfma_f32_32x32x16_bf16 v[100:115], v[152:155], v[36:39], v[100:115]
    v_mfma_f32_32x32x16_bf16 v[116:131], v[156:159], v[36:39], v[116:131]
    v_mfma_f32_32x32x16_bf16 v[132:147], v[160:163], v[36:39], v[132:147]
    ds_read_b64_tr_b16 v[148:149], v190 offset:8192
    ds_read_b64_tr_b16 v[150:151], v190 offset:9216
    ds_read_b64_tr_b16 v[152:153], v190 offset:8704
    ds_read_b64_tr_b16 v[154:155], v190 offset:9728
    ds_read_b64_tr_b16 v[156:157], v194 offset:8192
    ds_read_b64_tr_b16 v[158:159], v194 offset:9216
    ds_read_b64_tr_b16 v[160:161], v194 offset:8704
    ds_read_b64_tr_b16 v[162:163], v194 offset:9728
    s_waitcnt lgkmcnt(8)
    v_mfma_f32_32x32x16_bf16 v[84:99], v[164:167], v[40:43], v[84:99]
    v_mfma_f32_32x32x16_bf16 v[100:115], v[168:171], v[40:43], v[100:115]
    v_mfma_f32_32x32x16_bf16 v[116:131], v[172:175], v[40:43], v[116:131]
    v_mfma_f32_32x32x16_bf16 v[132:147], v[176:179], v[40:43], v[132:147]
    ds_read_b64_tr_b16 v[164:165], v191 offset:8192
    ds_read_b64_tr_b16 v[166:167], v191 offset:9216
    ds_read_b64_tr_b16 v[168:169], v191 offset:8704
    ds_read_b64_tr_b16 v[170:171], v191 offset:9728
    ds_read_b64_tr_b16 v[172:173], v195 offset:8192
    ds_read_b64_tr_b16 v[174:175], v195 offset:9216
    ds_read_b64_tr_b16 v[176:177], v195 offset:8704
    ds_read_b64_tr_b16 v[178:179], v195 offset:9728
    s_waitcnt lgkmcnt(8)
    v_mfma_f32_32x32x16_bf16 v[84:99], v[148:151], v[44:47], v[84:99]
    v_mfma_f32_32x32x16_bf16 v[100:115], v[152:155], v[44:47], v[100:115]
    v_mfma_f32_32x32x16_bf16 v[116:131], v[156:159], v[44:47], v[116:131]
    v_mfma_f32_32x32x16_bf16 v[132:147], v[160:163], v[44:47], v[132:147]
    ds_read_b64_tr_b16 v[148:149], v188 offset:16384
    ds_read_b64_tr_b16 v[150:151], v188 offset:17408
    ds_read_b64_tr_b16 v[152:153], v188 offset:16896
    ds_read_b64_tr_b16 v[154:155], v188 offset:17920
    ds_read_b64_tr_b16 v[156:157], v192 offset:16384
    ds_read_b64_tr_b16 v[158:159], v192 offset:17408
    ds_read_b64_tr_b16 v[160:161], v192 offset:16896
    ds_read_b64_tr_b16 v[162:163], v192 offset:17920
    s_waitcnt lgkmcnt(8)
    v_mfma_f32_32x32x16_bf16 v[84:99], v[164:167], v[48:51], v[84:99]
    v_mfma_f32_32x32x16_bf16 v[100:115], v[168:171], v[48:51], v[100:115]
    v_mfma_f32_32x32x16_bf16 v[116:131], v[172:175], v[48:51], v[116:131]
    v_mfma_f32_32x32x16_bf16 v[132:147], v[176:179], v[48:51], v[132:147]
    ds_read_b64_tr_b16 v[164:165], v189 offset:16384
    ds_read_b64_tr_b16 v[166:167], v189 offset:17408
    ds_read_b64_tr_b16 v[168:169], v189 offset:16896
    ds_read_b64_tr_b16 v[170:171], v189 offset:17920
    ds_read_b64_tr_b16 v[172:173], v193 offset:16384
    ds_read_b64_tr_b16 v[174:175], v193 offset:17408
    ds_read_b64_tr_b16 v[176:177], v193 offset:16896
    ds_read_b64_tr_b16 v[178:179], v193 offset:17920
    s_waitcnt lgkmcnt(8)
    s_waitcnt vmcnt(4)
    v_mfma_f32_32x32x16_bf16 v[84:99], v[148:151], v[52:55], v[84:99]
    v_mfma_f32_32x32x16_bf16 v[100:115], v[152:155], v[52:55], v[100:115]
    v_mfma_f32_32x32x16_bf16 v[116:131], v[156:159], v[52:55], v[116:131]
    v_mfma_f32_32x32x16_bf16 v[132:147], v[160:163], v[52:55], v[132:147]
    ds_read_b64_tr_b16 v[148:149], v190 offset:16384
    ds_read_b64_tr_b16 v[150:151], v190 offset:17408
    ds_read_b64_tr_b16 v[152:153], v190 offset:16896
    ds_read_b64_tr_b16 v[154:155], v190 offset:17920
    ds_read_b64_tr_b16 v[156:157], v194 offset:16384
    ds_read_b64_tr_b16 v[158:159], v194 offset:17408
    ds_read_b64_tr_b16 v[160:161], v194 offset:16896
    ds_read_b64_tr_b16 v[162:163], v194 offset:17920
    s_waitcnt lgkmcnt(8)
    v_mfma_f32_32x32x16_bf16 v[84:99], v[164:167], v[56:59], v[84:99]
    v_mfma_f32_32x32x16_bf16 v[100:115], v[168:171], v[56:59], v[100:115]
    v_mfma_f32_32x32x16_bf16 v[116:131], v[172:175], v[56:59], v[116:131]
    v_mfma_f32_32x32x16_bf16 v[132:147], v[176:179], v[56:59], v[132:147]
    ds_read_b64_tr_b16 v[164:165], v191 offset:16384
    ds_read_b64_tr_b16 v[166:167], v191 offset:17408
    ds_read_b64_tr_b16 v[168:169], v191 offset:16896
    ds_read_b64_tr_b16 v[170:171], v191 offset:17920
    ds_read_b64_tr_b16 v[172:173], v195 offset:16384
    ds_read_b64_tr_b16 v[174:175], v195 offset:17408
    ds_read_b64_tr_b16 v[176:177], v195 offset:16896
    ds_read_b64_tr_b16 v[178:179], v195 offset:17920
    s_waitcnt lgkmcnt(8)
    v_mfma_f32_32x32x16_bf16 v[84:99], v[148:151], v[60:63], v[84:99]
    v_mfma_f32_32x32x16_bf16 v[100:115], v[152:155], v[60:63], v[100:115]
    v_mfma_f32_32x32x16_bf16 v[116:131], v[156:159], v[60:63], v[116:131]
    v_mfma_f32_32x32x16_bf16 v[132:147], v[160:163], v[60:63], v[132:147]
    ds_read_b64_tr_b16 v[148:149], v188 offset:24576
    ds_read_b64_tr_b16 v[150:151], v188 offset:25600
    ds_read_b64_tr_b16 v[152:153], v188 offset:25088
    ds_read_b64_tr_b16 v[154:155], v188 offset:26112
    ds_read_b64_tr_b16 v[156:157], v192 offset:24576
    ds_read_b64_tr_b16 v[158:159], v192 offset:25600
    ds_read_b64_tr_b16 v[160:161], v192 offset:25088
    ds_read_b64_tr_b16 v[162:163], v192 offset:26112
    s_waitcnt lgkmcnt(8)
    v_mfma_f32_32x32x16_bf16 v[84:99], v[164:167], v[64:67], v[84:99]
    v_mfma_f32_32x32x16_bf16 v[100:115], v[168:171], v[64:67], v[100:115]
    v_mfma_f32_32x32x16_bf16 v[116:131], v[172:175], v[64:67], v[116:131]
    v_mfma_f32_32x32x16_bf16 v[132:147], v[176:179], v[64:67], v[132:147]
    ds_read_b64_tr_b16 v[164:165], v189 offset:24576
    ds_read_b64_tr_b16 v[166:167], v189 offset:25600
    ds_read_b64_tr_b16 v[168:169], v189 offset:25088
    ds_read_b64_tr_b16 v[170:171], v189 offset:26112
    ds_read_b64_tr_b16 v[172:173], v193 offset:24576
    ds_read_b64_tr_b16 v[174:175], v193 offset:25600
    ds_read_b64_tr_b16 v[176:177], v193 offset:25088
    ds_read_b64_tr_b16 v[178:179], v193 offset:26112
    s_waitcnt lgkmcnt(8)
    s_waitcnt vmcnt(0)
    v_mfma_f32_32x32x16_bf16 v[84:99], v[148:151], v[68:71], v[84:99]
    v_mfma_f32_32x32x16_bf16 v[100:115], v[152:155], v[68:71], v[100:115]
    v_mfma_f32_32x32x16_bf16 v[116:131], v[156:159], v[68:71], v[116:131]
    v_mfma_f32_32x32x16_bf16 v[132:147], v[160:163], v[68:71], v[132:147]
    ds_read_b64_tr_b16 v[148:149], v190 offset:24576
    ds_read_b64_tr_b16 v[150:151], v190 offset:25600
    ds_read_b64_tr_b16 v[152:153], v190 offset:25088
    ds_read_b64_tr_b16 v[154:155], v190 offset:26112
    ds_read_b64_tr_b16 v[156:157], v194 offset:24576
    ds_read_b64_tr_b16 v[158:159], v194 offset:25600
    ds_read_b64_tr_b16 v[160:161], v194 offset:25088
    ds_read_b64_tr_b16 v[162:163], v194 offset:26112
    s_waitcnt lgkmcnt(8)
    v_mfma_f32_32x32x16_bf16 v[84:99], v[164:167], v[72:75], v[84:99]
    v_mfma_f32_32x32x16_bf16 v[100:115], v[168:171], v[72:75], v[100:115]
    v_mfma_f32_32x32x16_bf16 v[116:131], v[172:175], v[72:75], v[116:131]
    v_mfma_f32_32x32x16_bf16 v[132:147], v[176:179], v[72:75], v[132:147]
    ds_read_b64_tr_b16 v[164:165], v191 offset:24576
    ds_read_b64_tr_b16 v[166:167], v191 offset:25600
    ds_read_b64_tr_b16 v[168:169], v191 offset:25088
    ds_read_b64_tr_b16 v[170:171], v191 offset:26112
    ds_read_b64_tr_b16 v[172:173], v195 offset:24576
    ds_read_b64_tr_b16 v[174:175], v195 offset:25600
    ds_read_b64_tr_b16 v[176:177], v195 offset:25088
    ds_read_b64_tr_b16 v[178:179], v195 offset:26112
    s_waitcnt lgkmcnt(8)
    v_mfma_f32_32x32x16_bf16 v[84:99], v[148:151], v[76:79], v[84:99]
    v_mfma_f32_32x32x16_bf16 v[100:115], v[152:155], v[76:79], v[100:115]
    v_mfma_f32_32x32x16_bf16 v[116:131], v[156:159], v[76:79], v[116:131]
    v_mfma_f32_32x32x16_bf16 v[132:147], v[160:163], v[76:79], v[132:147]
    s_waitcnt lgkmcnt(0)
    v_mfma_f32_32x32x16_bf16 v[84:99], v[164:167], v[80:83], v[84:99]
    v_mfma_f32_32x32x16_bf16 v[100:115], v[168:171], v[80:83], v[100:115]
    v_mfma_f32_32x32x16_bf16 v[116:131], v[172:175], v[80:83], v[116:131]
    v_mfma_f32_32x32x16_bf16 v[132:147], v[176:179], v[80:83], v[132:147]
    v_add_f32 v196, v196, v200
    v_add_f32 v197, v197, v201
    v_add_f32 v198, v198, v202
    v_add_f32 v199, v199, v203
    v_add_f32 v196, v196, v198
    v_add_f32 v197, v197, v199
    v_mov_b32 v3, v196
    s_nop 1
    v_permlane32_swap_b32 v196, v3
    v_add_f32 v196, v196, v3
    v_mov_b32 v4, v197
    s_nop 1
    v_permlane32_swap_b32 v197, v4
    v_add_f32 v197, v197, v4
    s_waitcnt lgkmcnt(0)
    s_barrier
    s_lshl_b32 s40, s36, 13
    s_add_u32 s40, s40, 65536
    v_add_u32 v2, s40, v7
    s_cmp_eq_u32 s56, 0
    s_cbranch_scc1 KM_E1
    ds_write_b128 v2, v[84:87] offset:0
    ds_write_b128 v2, v[88:91] offset:1024
    ds_write_b128 v2, v[92:95] offset:2048
    ds_write_b128 v2, v[96:99] offset:3072
    ds_write_b128 v2, v[100:103] offset:4096
    ds_write_b128 v2, v[104:107] offset:5120
    ds_write_b128 v2, v[108:111] offset:6144
    ds_write_b128 v2, v[112:115] offset:7168
    v_mov_b32 v84, v116
    v_mov_b32 v85, v117
    v_mov_b32 v86, v118
    v_mov_b32 v87, v119
    v_mov_b32 v88, v120
    v_mov_b32 v89, v121
    v_mov_b32 v90, v122
    v_mov_b32 v91, v123
    v_mov_b32 v92, v124
    v_mov_b32 v93, v125
    v_mov_b32 v94, v126
    v_mov_b32 v95, v127
    v_mov_b32 v96, v128
    v_mov_b32 v97, v129
    v_mov_b32 v98, v130
    v_mov_b32 v99, v131
    v_mov_b32 v100, v132
    v_mov_b32 v101, v133
    v_mov_b32 v102, v134
    v_mov_b32 v103, v135
    v_mov_b32 v104, v136
    v_mov_b32 v105, v137
    v_mov_b32 v106, v138
    v_mov_b32 v107, v139
    v_mov_b32 v108, v140
    v_mov_b32 v109, v141
    v_mov_b32 v110, v142
    v_mov_b32 v111, v143
    v_mov_b32 v112, v144
    v_mov_b32 v113, v145
    v_mov_b32 v114, v146
    v_mov_b32 v115, v147
    s_branch KM_E2
KM_E1:
    ds_write_b128 v2, v[116:119] offset:0
    ds_write_b128 v2, v[120:123] offset:1024
    ds_write_b128 v2, v[124:127] offset:2048
    ds_write_b128 v2, v[128:131] offset:3072
    ds_write_b128 v2, v[132:135] offset:4096
    ds_write_b128 v2, v[136:139] offset:5120
    ds_write_b128 v2, v[140:143] offset:6144
    ds_write_b128 v2, v[144:147] offset:7168
KM_E2:
    s_waitcnt lgkmcnt(0)
    s_barrier
    s_xor_b32 s40, s36, 4
    s_lshl_b32 s40, s40, 13
    s_add_u32 s40, s40, 65536
    v_add_u32 v2, s40, v7
    ds_read_b128 v[116:119], v2 offset:0
    ds_read_b128 v[120:123], v2 offset:1024
    ds_read_b128 v[124:127], v2 offset:2048
    ds_read_b128 v[128:131], v2 offset:3072
    ds_read_b128 v[132:135], v2 offset:4096
    ds_read_b128 v[136:139], v2 offset:5120
    ds_read_b128 v[140:143], v2 offset:6144
    ds_read_b128 v[144:147], v2 offset:7168
    s_lshl_b32 s40, s56, 8
    s_add_u32 s40, s40, 139264
    v_lshl_add_u32 v4, v5, 4, s40
    ds_read_b128 v[20:23], v4 offset:0
    ds_read_b128 v[24:27], v4 offset:32
    ds_read_b128 v[28:31], v4 offset:64
    ds_read_b128 v[32:35], v4 offset:96
    ds_read_b128 v[36:39], v4 offset:128
    ds_read_b128 v[40:43], v4 offset:160
    ds_read_b128 v[44:47], v4 offset:192
    ds_read_b128 v[48:51], v4 offset:224
    s_waitcnt lgkmcnt(8)
    v_mul_f32 v180, 0x3b000000, v196
    v_mul_f32 v3, v180, v180
    v_mov_b32 v2, 0x3b000000
    v_fma_f32 v3, v197, v2, -v3
    v_max_f32 v3, 0, v3
    v_add_f32 v198, 0x3727c5ac, v3
    v_rcp_f32 v2, v198
    v_rsq_f32 v181, v198
    v_mul_f32 v3, v3, v2
    v_add_f32 v3, 0x3727c5ac, v3
    v_rsq_f32 v3, v3
    v_mov_b32 v184, 0xc0135761
    v_mov_b32 v185, 0xbdd2d3e8
    v_mul_f32 v181, v181, v3
    v_mul_f32 v182, v180, v181
    ds_read_b128 v[52:55], v4 offset:512
    ds_read_b128 v[56:59], v4 offset:544
    ds_read_b128 v[60:63], v4 offset:576
    ds_read_b128 v[64:67], v4 offset:608
    ds_read_b128 v[68:71], v4 offset:640
    ds_read_b128 v[72:75], v4 offset:672
    ds_read_b128 v[76:79], v4 offset:704
    ds_read_b128 v[80:83], v4 offset:736
    v_add_f32 v84, v84, v116
    v_add_f32 v85, v85, v117
    v_add_f32 v86, v86, v118
    v_add_f32 v87, v87, v119
    v_add_f32 v88, v88, v120
    v_add_f32 v89, v89, v121
    v_add_f32 v90, v90, v122
    v_add_f32 v91, v91, v123
    v_add_f32 v92, v92, v124
    v_add_f32 v93, v93, v125
    v_add_f32 v94, v94, v126
    v_add_f32 v95, v95, v127
    v_add_f32 v96, v96, v128
    v_add_f32 v97, v97, v129
    v_add_f32 v98, v98, v130
    v_add_f32 v99, v99, v131
    v_add_f32 v100, v100, v132
    v_add_f32 v101, v101, v133
    v_add_f32 v102, v102, v134
    v_add_f32 v103, v103, v135
    v_add_f32 v104, v104, v136
    v_add_f32 v105, v105, v137
    v_add_f32 v106, v106, v138
    v_add_f32 v107, v107, v139
    v_add_f32 v108, v108, v140
    v_add_f32 v109, v109, v141
    v_add_f32 v110, v110, v142
    v_add_f32 v111, v111, v143
    v_add_f32 v112, v112, v144
    v_add_f32 v113, v113, v145
    v_add_f32 v114, v114, v146
    v_add_f32 v115, v115, v147
    s_mul_i32 s42, s74, 114688
    s_lshl_b32 s40, s53, 13
    s_add_u32 s42, s42, s40
    s_lshl_b32 s40, s56, 12
    s_add_u32 s42, s42, s40
    s_add_u32 s42, s42, 12582912
    s_waitcnt lgkmcnt(0)
    v_fma_f32 v52, -v182, v20, v52
    v_fma_f32 v53, -v182, v21, v53
    v_fma_f32 v54, -v182, v22, v54
    v_fma_f32 v55, -v182, v23, v55
    v_fma_f32 v56, -v182, v24, v56
    v_fma_f32 v57, -v182, v25, v57
    v_fma_f32 v58, -v182, v26, v58
    v_fma_f32 v59, -v182, v27, v59
    v_fma_f32 v60, -v182, v28, v60
    v_fma_f32 v61, -v182, v29, v61
    v_fma_f32 v62, -v182, v30, v62
    v_fma_f32 v63, -v182, v31, v63
    v_fma_f32 v64, -v182, v32, v64
    v_fma_f32 v65, -v182, v33, v65
    v_fma_f32 v66, -v182, v34, v66
    v_fma_f32 v67, -v182, v35, v67
    v_fma_f32 v84, v84, v181, v52
    v_fma_f32 v85, v85, v181, v53
    v_fma_f32 v86, v86, v181, v54
    v_fma_f32 v87, v87, v181, v55
    v_fma_f32 v88, v88, v181, v56
    v_fma_f32 v89, v89, v181, v57
    v_fma_f32 v90, v90, v181, v58
    v_fma_f32 v91, v91, v181, v59
    v_fma_f32 v92, v92, v181, v60
    v_fma_f32 v93, v93, v181, v61
    v_fma_f32 v94, v94, v181, v62
    v_fma_f32 v95, v95, v181, v63
    v_fma_f32 v96, v96, v181, v64
    v_fma_f32 v97, v97, v181, v65
    v_fma_f32 v98, v98, v181, v66
    v_fma_f32 v99, v99, v181, v67
    v_mul_f32 v116, v84, v84
    v_mul_f32 v117, v85, v85
    v_mul_f32 v118, v86, v86
    v_mul_f32 v119, v87, v87
    v_mul_f32 v120, v88, v88
    v_mul_f32 v121, v89, v89
    v_mul_f32 v122, v90, v90
    v_mul_f32 v123, v91, v91
    v_mul_f32 v124, v92, v92
    v_mul_f32 v125, v93, v93
    v_mul_f32 v126, v94, v94
    v_mul_f32 v127, v95, v95
    v_mul_f32 v128, v96, v96
    v_mul_f32 v129, v97, v97
    v_mul_f32 v130, v98, v98
    v_mul_f32 v131, v99, v99
    v_fma_f32 v116, v116, v185, v184
    v_fma_f32 v117, v117, v185, v184
    v_fma_f32 v118, v118, v185, v184
    v_fma_f32 v119, v119, v185, v184
    v_fma_f32 v120, v120, v185, v184
    v_fma_f32 v121, v121, v185, v184
    v_fma_f32 v122, v122, v185, v184
    v_fma_f32 v123, v123, v185, v184
    v_fma_f32 v124, v124, v185, v184
    v_fma_f32 v125, v125, v185, v184
    v_fma_f32 v126, v126, v185, v184
    v_fma_f32 v127, v127, v185, v184
    v_fma_f32 v128, v128, v185, v184
    v_fma_f32 v129, v129, v185, v184
    v_fma_f32 v130, v130, v185, v184
    v_fma_f32 v131, v131, v185, v184
    v_mul_f32 v116, v116, v84
    v_mul_f32 v117, v117, v85
    v_mul_f32 v118, v118, v86
    v_mul_f32 v119, v119, v87
    v_mul_f32 v120, v120, v88
    v_mul_f32 v121, v121, v89
    v_mul_f32 v122, v122, v90
    v_mul_f32 v123, v123, v91
    v_mul_f32 v124, v124, v92
    v_mul_f32 v125, v125, v93
    v_mul_f32 v126, v126, v94
    v_mul_f32 v127, v127, v95
    v_mul_f32 v128, v128, v96
    v_mul_f32 v129, v129, v97
    v_mul_f32 v130, v130, v98
    v_mul_f32 v131, v131, v99
    v_exp_f32 v116, v116
    v_exp_f32 v117, v117
    v_exp_f32 v118, v118
    v_exp_f32 v119, v119
    v_exp_f32 v120, v120
    v_exp_f32 v121, v121
    v_exp_f32 v122, v122
    v_exp_f32 v123, v123
    v_exp_f32 v124, v124
    v_exp_f32 v125, v125
    v_exp_f32 v126, v126
    v_exp_f32 v127, v127
    v_exp_f32 v128, v128
    v_exp_f32 v129, v129
    v_exp_f32 v130, v130
    v_exp_f32 v131, v131
    v_add_f32 v116, 1.0, v116
    v_add_f32 v117, 1.0, v117
    v_add_f32 v118, 1.0, v118
    v_add_f32 v119, 1.0, v119
    v_add_f32 v120, 1.0, v120
    v_add_f32 v121, 1.0, v121
    v_add_f32 v122, 1.0, v122
    v_add_f32 v123, 1.0, v123
    v_add_f32 v124, 1.0, v124
    v_add_f32 v125, 1.0, v125
    v_add_f32 v126, 1.0, v126
    v_add_f32 v127, 1.0, v127
    v_add_f32 v128, 1.0, v128
    v_add_f32 v129, 1.0, v129
    v_add_f32 v130, 1.0, v130
    v_add_f32 v131, 1.0, v131
    v_rcp_f32 v116, v116
    v_rcp_f32 v117, v117
    v_rcp_f32 v118, v118
    v_rcp_f32 v119, v119
    v_rcp_f32 v120, v120
    v_rcp_f32 v121, v121
    v_rcp_f32 v122, v122
    v_rcp_f32 v123, v123
    v_rcp_f32 v124, v124
    v_rcp_f32 v125, v125
    v_rcp_f32 v126, v126
    v_rcp_f32 v127, v127
    v_rcp_f32 v128, v128
    v_rcp_f32 v129, v129
    v_rcp_f32 v130, v130
    v_rcp_f32 v131, v131
    v_mul_f32 v84, v84, v116
    v_mul_f32 v85, v85, v117
    v_mul_f32 v86, v86, v118
    v_mul_f32 v87, v87, v119
    v_mul_f32 v88, v88, v120
    v_mul_f32 v89, v89, v121
    v_mul_f32 v90, v90, v122
    v_mul_f32 v91, v91, v123
    v_mul_f32 v92, v92, v124
    v_mul_f32 v93, v93, v125
    v_mul_f32 v94, v94, v126
    v_mul_f32 v95, v95, v127
    v_mul_f32 v96, v96, v128
    v_mul_f32 v97, v97, v129
    v_mul_f32 v98, v98, v130
    v_mul_f32 v99, v99, v131
    v_cvt_pk_bf16_f32 v20, v84, v85
    v_cvt_pk_bf16_f32 v21, v86, v87
    v_cvt_pk_bf16_f32 v22, v88, v89
    v_cvt_pk_bf16_f32 v23, v90, v91
    v_cvt_pk_bf16_f32 v24, v92, v93
    v_cvt_pk_bf16_f32 v25, v94, v95
    v_cvt_pk_bf16_f32 v26, v96, v97
    v_cvt_pk_bf16_f32 v27, v98, v99
    buffer_store_dwordx4 v[20:23], v7, s[24:27], s42 offen offset:0 sc1
    buffer_store_dwordx4 v[24:27], v7, s[24:27], s42 offen offset:1024 sc1
    v_fma_f32 v68, -v182, v36, v68
    v_fma_f32 v69, -v182, v37, v69
    v_fma_f32 v70, -v182, v38, v70
    v_fma_f32 v71, -v182, v39, v71
    v_fma_f32 v72, -v182, v40, v72
    v_fma_f32 v73, -v182, v41, v73
    v_fma_f32 v74, -v182, v42, v74
    v_fma_f32 v75, -v182, v43, v75
    v_fma_f32 v76, -v182, v44, v76
    v_fma_f32 v77, -v182, v45, v77
    v_fma_f32 v78, -v182, v46, v78
    v_fma_f32 v79, -v182, v47, v79
    v_fma_f32 v80, -v182, v48, v80
    v_fma_f32 v81, -v182, v49, v81
    v_fma_f32 v82, -v182, v50, v82
    v_fma_f32 v83, -v182, v51, v83
    v_fma_f32 v100, v100, v181, v68
    v_fma_f32 v101, v101, v181, v69
    v_fma_f32 v102, v102, v181, v70
    v_fma_f32 v103, v103, v181, v71
    v_fma_f32 v104, v104, v181, v72
    v_fma_f32 v105, v105, v181, v73
    v_fma_f32 v106, v106, v181, v74
    v_fma_f32 v107, v107, v181, v75
    v_fma_f32 v108, v108, v181, v76
    v_fma_f32 v109, v109, v181, v77
    v_fma_f32 v110, v110, v181, v78
    v_fma_f32 v111, v111, v181, v79
    v_fma_f32 v112, v112, v181, v80
    v_fma_f32 v113, v113, v181, v81
    v_fma_f32 v114, v114, v181, v82
    v_fma_f32 v115, v115, v181, v83
    v_mul_f32 v132, v100, v100
    v_mul_f32 v133, v101, v101
    v_mul_f32 v134, v102, v102
    v_mul_f32 v135, v103, v103
    v_mul_f32 v136, v104, v104
    v_mul_f32 v137, v105, v105
    v_mul_f32 v138, v106, v106
    v_mul_f32 v139, v107, v107
    v_mul_f32 v140, v108, v108
    v_mul_f32 v141, v109, v109
    v_mul_f32 v142, v110, v110
    v_mul_f32 v143, v111, v111
    v_mul_f32 v144, v112, v112
    v_mul_f32 v145, v113, v113
    v_mul_f32 v146, v114, v114
    v_mul_f32 v147, v115, v115
    v_fma_f32 v132, v132, v185, v184
    v_fma_f32 v133, v133, v185, v184
    v_fma_f32 v134, v134, v185, v184
    v_fma_f32 v135, v135, v185, v184
    v_fma_f32 v136, v136, v185, v184
    v_fma_f32 v137, v137, v185, v184
    v_fma_f32 v138, v138, v185, v184
    v_fma_f32 v139, v139, v185, v184
    v_fma_f32 v140, v140, v185, v184
    v_fma_f32 v141, v141, v185, v184
    v_fma_f32 v142, v142, v185, v184
    v_fma_f32 v143, v143, v185, v184
    v_fma_f32 v144, v144, v185, v184
    v_fma_f32 v145, v145, v185, v184
    v_fma_f32 v146, v146, v185, v184
    v_fma_f32 v147, v147, v185, v184
    v_mul_f32 v132, v132, v100
    v_mul_f32 v133, v133, v101
    v_mul_f32 v134, v134, v102
    v_mul_f32 v135, v135, v103
    v_mul_f32 v136, v136, v104
    v_mul_f32 v137, v137, v105
    v_mul_f32 v138, v138, v106
    v_mul_f32 v139, v139, v107
    v_mul_f32 v140, v140, v108
    v_mul_f32 v141, v141, v109
    v_mul_f32 v142, v142, v110
    v_mul_f32 v143, v143, v111
    v_mul_f32 v144, v144, v112
    v_mul_f32 v145, v145, v113
    v_mul_f32 v146, v146, v114
    v_mul_f32 v147, v147, v115
    v_exp_f32 v132, v132
    v_exp_f32 v133, v133
    v_exp_f32 v134, v134
    v_exp_f32 v135, v135
    v_exp_f32 v136, v136
    v_exp_f32 v137, v137
    v_exp_f32 v138, v138
    v_exp_f32 v139, v139
    v_exp_f32 v140, v140
    v_exp_f32 v141, v141
    v_exp_f32 v142, v142
    v_exp_f32 v143, v143
    v_exp_f32 v144, v144
    v_exp_f32 v145, v145
    v_exp_f32 v146, v146
    v_exp_f32 v147, v147
    v_add_f32 v132, 1.0, v132
    v_add_f32 v133, 1.0, v133
    v_add_f32 v134, 1.0, v134
    v_add_f32 v135, 1.0, v135
    v_add_f32 v136, 1.0, v136
    v_add_f32 v137, 1.0, v137
    v_add_f32 v138, 1.0, v138
    v_add_f32 v139, 1.0, v139
    v_add_f32 v140, 1.0, v140
    v_add_f32 v141, 1.0, v141
    v_add_f32 v142, 1.0, v142
    v_add_f32 v143, 1.0, v143
    v_add_f32 v144, 1.0, v144
    v_add_f32 v145, 1.0, v145
    v_add_f32 v146, 1.0, v146
    v_add_f32 v147, 1.0, v147
    v_rcp_f32 v132, v132
    v_rcp_f32 v133, v133
    v_rcp_f32 v134, v134
    v_rcp_f32 v135, v135
    v_rcp_f32 v136, v136
    v_rcp_f32 v137, v137
    v_rcp_f32 v138, v138
    v_rcp_f32 v139, v139
    v_rcp_f32 v140, v140
    v_rcp_f32 v141, v141
    v_rcp_f32 v142, v142
    v_rcp_f32 v143, v143
    v_rcp_f32 v144, v144
    v_rcp_f32 v145, v145
    v_rcp_f32 v146, v146
    v_rcp_f32 v147, v147
    v_mul_f32 v100, v100, v132
    v_mul_f32 v101, v101, v133
    v_mul_f32 v102, v102, v134
    v_mul_f32 v103, v103, v135
    v_mul_f32 v104, v104, v136
    v_mul_f32 v105, v105, v137
    v_mul_f32 v106, v106, v138
    v_mul_f32 v107, v107, v139
    v_mul_f32 v108, v108, v140
    v_mul_f32 v109, v109, v141
    v_mul_f32 v110, v110, v142
    v_mul_f32 v111, v111, v143
    v_mul_f32 v112, v112, v144
    v_mul_f32 v113, v113, v145
    v_mul_f32 v114, v114, v146
    v_mul_f32 v115, v115, v147
    v_cvt_pk_bf16_f32 v36, v100, v101
    v_cvt_pk_bf16_f32 v37, v102, v103
    v_cvt_pk_bf16_f32 v38, v104, v105
    v_cvt_pk_bf16_f32 v39, v106, v107
    v_cvt_pk_bf16_f32 v40, v108, v109
    v_cvt_pk_bf16_f32 v41, v110, v111
    v_cvt_pk_bf16_f32 v42, v112, v113
    v_cvt_pk_bf16_f32 v43, v114, v115
    buffer_store_dwordx4 v[36:39], v7, s[24:27], s42 offen offset:2048 sc1
    buffer_store_dwordx4 v[40:43], v7, s[24:27], s42 offen offset:3072 sc1
    s_lshr_b32 s41, s36, 2
    s_mul_i32 s42, s41, 458752
    s_lshl_b32 s40, s51, 7
    s_add_u32 s42, s42, s40
    s_lshl_b32 s40, s37, 16
    s_add_u32 s42, s42, s40
    s_lshl_b32 s41, s36, 13
    s_add_u32 m0, s41, 0
    s_add_u32 s40, s42, 0
    buffer_load_dwordx4 v17, s[64:67], s40 offen lds
    s_add_u32 m0, s41, 1024
    s_add_u32 s40, s42, 8192
    buffer_load_dwordx4 v17, s[64:67], s40 offen lds
    s_add_u32 m0, s41, 2048
    s_add_u32 s40, s42, 16384
    buffer_load_dwordx4 v17, s[64:67], s40 offen lds
    s_add_u32 m0, s41, 3072
    s_add_u32 s40, s42, 24576
    buffer_load_dwordx4 v17, s[64:67], s40 offen lds
    s_add_u32 m0, s41, 4096
    s_add_u32 s40, s42, 32768
    buffer_load_dwordx4 v17, s[64:67], s40 offen lds
    s_add_u32 m0, s41, 5120
    s_add_u32 s40, s42, 40960
    buffer_load_dwordx4 v17, s[64:67], s40 offen lds
    s_add_u32 m0, s41, 6144
    s_add_u32 s40, s42, 49152
    buffer_load_dwordx4 v17, s[64:67], s40 offen lds
    s_add_u32 m0, s41, 7168
    s_add_u32 s40, s42, 57344
    buffer_load_dwordx4 v17, s[64:67], s40 offen lds
    s_waitcnt vmcnt(8)
    s_barrier
    s_cmp_lg_u32 s36, 0
    s_cbranch_scc1 KM_NW0_4s
    s_mov_b32 s45, s52
    s_lshl_b32 s45, s45, 8
    s_add_u32 s45, s45, 22026240
    v_mov_b32 v2, 1
    v_mov_b32 v3, 0
    s_mov_b64 exec, 1
    buffer_atomic_add v2, v3, s[24:27], s45 offen sc1
    s_mov_b64 exec, -1
KM_NW0_4s:
KM_NOP4:
    s_cmp_lt_u32 s36, 4
    s_cbranch_scc1 KM_NU_w2
    s_lshr_b32 s41, s37, 1
    s_add_u32 s41, s41, 2
    s_mul_i32 s42, s41, 458752
    s_lshl_b32 s40, s51, 7
    s_add_u32 s42, s42, s40
    s_and_b32 s40, s37, 1
    s_lshl_b32 s40, s40, 17
    s_add_u32 s42, s42, s40
    s_lshl_b32 s41, s37, 14
    s_add_u32 m0, s41, 65536
    s_add_u32 s40, s42, 0
    buffer_load_dwordx4 v17, s[64:67], s40 offen lds
    s_add_u32 m0, s41, 66560
    s_add_u32 s40, s42, 8192
    buffer_load_dwordx4 v17, s[64:67], s40 offen lds
    s_add_u32 m0, s41, 67584
    s_add_u32 s40, s42, 16384
    buffer_load_dwordx4 v17, s[64:67], s40 offen lds
    s_add_u32 m0, s41, 68608
    s_add_u32 s40, s42, 24576
    buffer_load_dwordx4 v17, s[64:67], s40 offen lds
    s_add_u32 m0, s41, 69632
    s_add_u32 s40, s42, 32768
    buffer_load_dwordx4 v17, s[64:67], s40 offen lds
    s_add_u32 m0, s41, 70656
    s_add_u32 s40, s42, 40960
    buffer_load_dwordx4 v17, s[64:67], s40 offen lds
    s_add_u32 m0, s41, 71680
    s_add_u32 s40, s42, 49152
    buffer_load_dwordx4 v17, s[64:67], s40 offen lds
    s_add_u32 m0, s41, 72704
    s_add_u32 s40, s42, 57344
    buffer_load_dwordx4 v17, s[64:67], s40 offen lds
    s_add_u32 m0, s41, 73728
    s_add_u32 s40, s42, 65536
    buffer_load_dwordx4 v17, s[64:67], s40 offen lds
    s_add_u32 m0, s41, 74752
    s_add_u32 s40, s42, 73728
    buffer_load_dwordx4 v17, s[64:67], s40 offen lds
    s_add_u32 m0, s41, 75776
    s_add_u32 s40, s42, 81920
    buffer_load_dwordx4 v17, s[64:67], s40 offen lds
    s_add_u32 m0, s41, 76800
    s_add_u32 s40, s42, 90112
    buffer_load_dwordx4 v17, s[64:67], s40 offen lds
    s_add_u32 m0, s41, 77824
    s_add_u32 s40, s42, 98304
    buffer_load_dwordx4 v17, s[64:67], s40 offen lds
    s_add_u32 m0, s41, 78848
    s_add_u32 s40, s42, 106496
    buffer_load_dwordx4 v17, s[64:67], s40 offen lds
    s_add_u32 m0, s41, 79872
    s_add_u32 s40, s42, 114688
    buffer_load_dwordx4 v17, s[64:67], s40 offen lds
    s_add_u32 m0, s41, 80896
    s_add_u32 s40, s42, 122880
    buffer_load_dwordx4 v17, s[64:67], s40 offen lds
KM_NU_w2:
    s_mov_b32 s28, s18
    s_and_b32 s29, s19, 0xffff
    s_mov_b32 s30, 1024
    s_mov_b32 s31, 0x20000
    s_mov_b32 s32, s20
    s_and_b32 s33, s21, 0xffff
    s_mov_b32 s34, 2097152
    s_mov_b32 s35, 0x20000
    s_lshl_b32 s40, s51, 7
    s_lshl_b32 s41, s54, 6
    s_add_u32 s40, s40, s41
    s_lshl_b32 s41, s56, 5
    s_add_u32 s40, s40, s41
    v_lshlrev_b32 v2, 3, v5
    buffer_load_dwordx2 v[200:201], v2, s[28:31], s40 offen offset:0
    buffer_load_dwordx2 v[202:203], v2, s[28:31], s40 offen offset:16
    s_cmp_lt_u32 s36, 4
    s_cbranch_scc1 KM_C5
    s_waitcnt vmcnt(0)
    s_barrier
    s_barrier
    s_lshl_b32 s41, s37, 15
    s_add_u32 m0, s41, 0
    s_add_u32 s40, s59, 262144
    buffer_load_dwordx4 v17, s[64:67], s40 offen lds
    s_add_u32 m0, s41, 1024
    s_add_u32 s40, s59, 270336
    buffer_load_dwordx4 v17, s[64:67], s40 offen lds
    s_add_u32 m0, s41, 2048
    s_add_u32 s40, s59, 278528
    buffer_load_dwordx4 v17, s[64:67], s40 offen lds
    s_add_u32 m0, s41, 3072
    s_add_u32 s40, s59, 286720
    buffer_load_dwordx4 v17, s[64:67], s40 offen lds
    s_add_u32 m0, s41, 4096
    s_add_u32 s40, s59, 294912
    buffer_load_dwordx4 v17, s[64:67], s40 offen lds
    s_add_u32 m0, s41, 5120
    s_add_u32 s40, s59, 303104
    buffer_load_dwordx4 v17, s[64:67], s40 offen lds
    s_add_u32 m0, s41, 6144
    s_add_u32 s40, s59, 311296
    buffer_load_dwordx4 v17, s[64:67], s40 offen lds
    s_add_u32 m0, s41, 7168
    s_add_u32 s40, s59, 319488
    buffer_load_dwordx4 v17, s[64:67], s40 offen lds
    s_barrier
    s_lshl_b32 s41, s37, 15
    s_add_u32 m0, s41, 8192
    s_add_u32 s40, s59, 327680
    buffer_load_dwordx4 v17, s[64:67], s40 offen lds
    s_add_u32 m0, s41, 9216
    s_add_u32 s40, s59, 335872
    buffer_load_dwordx4 v17, s[64:67], s40 offen lds
    s_add_u32 m0, s41, 10240
    s_add_u32 s40, s59, 344064
    buffer_load_dwordx4 v17, s[64:67], s40 offen lds
    s_add_u32 m0, s41, 11264
    s_add_u32 s40, s59, 352256
    buffer_load_dwordx4 v17, s[64:67], s40 offen lds
    s_add_u32 m0, s41, 12288
    s_add_u32 s40, s59, 360448
    buffer_load_dwordx4 v17, s[64:67], s40 offen lds
    s_add_u32 m0, s41, 13312
    s_add_u32 s40, s59, 368640
    buffer_load_dwordx4 v17, s[64:67], s40 offen lds
    s_add_u32 m0, s41, 14336
    s_add_u32 s40, s59, 376832
    buffer_load_dwordx4 v17, s[64:67], s40 offen lds
    s_add_u32 m0, s41, 15360
    s_add_u32 s40, s59, 385024
    buffer_load_dwordx4 v17, s[64:67], s40 offen lds
    s_barrier
    s_lshl_b32 s41, s37, 15
    s_add_u32 m0, s41, 16384
    s_add_u32 s40, s59, 393216
    buffer_load_dwordx4 v17, s[64:67], s40 offen lds
    s_add_u32 m0, s41, 17408
    s_add_u32 s40, s59, 401408
    buffer_load_dwordx4 v17, s[64:67], s40 offen lds
    s_add_u32 m0, s41, 18432
    s_add_u32 s40, s59, 409600
    buffer_load_dwordx4 v17, s[64:67], s40 offen lds
    s_add_u32 m0, s41, 19456
    s_add_u32 s40, s59, 417792
    buffer_load_dwordx4 v17, s[64:67], s40 offen lds
    s_add_u32 m0, s41, 20480
    s_add_u32 s40, s59, 425984
    buffer_load_dwordx4 v17, s[64:67], s40 offen lds
    s_add_u32 m0, s41, 21504
    s_add_u32 s40, s59, 434176
    buffer_load_dwordx4 v17, s[64:67], s40 offen lds
    s_add_u32 m0, s41, 22528
    s_add_u32 s40, s59, 442368
    buffer_load_dwordx4 v17, s[64:67], s40 offen lds
    s_add_u32 m0, s41, 23552
    s_add_u32 s40, s59, 450560
    buffer_load_dwordx4 v17, s[64:67], s40 offen lds
    s_waitcnt vmcnt(16)
    s_barrier
    s_waitcnt vmcnt(8)
    s_barrier
    s_waitcnt vmcnt(0)
    s_barrier
    s_barrier
    s_branch KM_Z
KM_C5:
    s_mul_i32 s80, s50, 229376
    s_mul_i32 s40, s37, 28672
    s_add_u32 s80, s80, s40
    s_add_u32 s80, s80, 12582912
    s_add_u32 s81, s80, 114688
    s_lshl_b32 s40, s37, 15
    v_add_u32 v196, s40, v16
    s_waitcnt vmcnt(0)
    s_cmp_lg_u32 s36, 0
    s_cbranch_scc1 KM_NW0_4
    s_lshl_b32 s45, s38, 1
    s_lshr_b32 s40, s43, 1
    s_add_u32 s45, s45, s40
    s_lshl_b32 s45, s45, 8
    s_add_u32 s45, s45, 22026240
    v_mov_b32 v3, 0
    s_mov_b32 s41, 3000000
KM_POLL_4:
    buffer_load_dword v2, v3, s[24:27], s45 offen sc1
    s_waitcnt vmcnt(0)
    v_readfirstlane_b32 s40, v2
    s_nop 0
    s_cmp_ge_u32 s40, 14
    s_cbranch_scc1 KM_PD_4
    s_sleep 1
    s_sub_u32 s41, s41, 1
    s_cmp_lg_u32 s41, 0
    s_cbranch_scc1 KM_POLL_4
KM_PD_4:
KM_NW0_4:
    s_barrier
    buffer_load_dwordx4 v[20:23], v7, s[24:27], s80 offen offset:0 sc1
    buffer_load_dwordx4 v[24:27], v7, s[24:27], s81 offen offset:0 sc1
    buffer_load_dwordx4 v[28:31], v7, s[24:27], s80 offen offset:1024 sc1
    buffer_load_dwordx4 v[32:35], v7, s[24:27], s81 offen offset:1024 sc1
    buffer_load_dwordx4 v[36:39], v7, s[24:27], s80 offen offset:2048 sc1
    buffer_load_dwordx4 v[40:43], v7, s[24:27], s81 offen offset:2048 sc1
    ds_read_b64_tr_b16 v[180:181], v196 offset:0
    ds_read_b64_tr_b16 v[182:183], v196 offset:1024
    ds_read_b64_tr_b16 v[184:185], v196 offset:512
    ds_read_b64_tr_b16 v[186:187], v196 offset:1536
    ds_read_b64_tr_b16 v[188:189], v196 offset:2048
    ds_read_b64_tr_b16 v[190:191], v196 offset:3072
    ds_read_b64_tr_b16 v[192:193], v196 offset:2560
    ds_read_b64_tr_b16 v[194:195], v196 offset:3584
    s_waitcnt lgkmcnt(4)
    s_waitcnt vmcnt(4)
    v_mfma_f32_32x32x16_bf16 v[116:131], v[180:183], v[20:23], 0
    v_mfma_f32_32x32x16_bf16 v[132:147], v[180:183], v[24:27], 0
    v_mfma_f32_32x32x16_bf16 v[148:163], v[184:187], v[20:23], 0
    v_mfma_f32_32x32x16_bf16 v[164:179], v[184:187], v[24:27], 0
    buffer_load_dwordx4 v[44:47], v7, s[24:27], s80 offen offset:3072 sc1
    buffer_load_dwordx4 v[48:51], v7, s[24:27], s81 offen offset:3072 sc1
    s_add_u32 s80, s80, 4096
    buffer_load_dwordx4 v[52:55], v7, s[24:27], s80 offen offset:0 sc1
    s_add_u32 s81, s81, 4096
    buffer_load_dwordx4 v[56:59], v7, s[24:27], s81 offen offset:0 sc1
    ds_read_b64_tr_b16 v[180:181], v196 offset:4096
    ds_read_b64_tr_b16 v[182:183], v196 offset:5120
    ds_read_b64_tr_b16 v[184:185], v196 offset:4608
    ds_read_b64_tr_b16 v[186:187], v196 offset:5632
    s_waitcnt lgkmcnt(4)
    s_waitcnt vmcnt(6)
    v_mfma_f32_32x32x16_bf16 v[116:131], v[188:191], v[28:31], v[116:131]
    v_mfma_f32_32x32x16_bf16 v[132:147], v[188:191], v[32:35], v[132:147]
    v_mfma_f32_32x32x16_bf16 v[148:163], v[192:195], v[28:31], v[148:163]
    v_mfma_f32_32x32x16_bf16 v[164:179], v[192:195], v[32:35], v[164:179]
    buffer_load_dwordx4 v[60:63], v7, s[24:27], s80 offen offset:1024 sc1
    buffer_load_dwordx4 v[64:67], v7, s[24:27], s81 offen offset:1024 sc1
    buffer_load_dwordx4 v[68:71], v7, s[24:27], s80 offen offset:2048 sc1
    buffer_load_dwordx4 v[72:75], v7, s[24:27], s81 offen offset:2048 sc1
    ds_read_b64_tr_b16 v[188:189], v196 offset:6144
    ds_read_b64_tr_b16 v[190:191], v196 offset:7168
    ds_read_b64_tr_b16 v[192:193], v196 offset:6656
    ds_read_b64_tr_b16 v[194:195], v196 offset:7680
    s_waitcnt lgkmcnt(4)
    s_waitcnt vmcnt(8)
    v_mfma_f32_32x32x16_bf16 v[116:131], v[180:183], v[36:39], v[116:131]
    v_mfma_f32_32x32x16_bf16 v[132:147], v[180:183], v[40:43], v[132:147]
    v_mfma_f32_32x32x16_bf16 v[148:163], v[184:187], v[36:39], v[148:163]
    v_mfma_f32_32x32x16_bf16 v[164:179], v[184:187], v[40:43], v[164:179]
    buffer_load_dwordx4 v[76:79], v7, s[24:27], s80 offen offset:3072 sc1
    buffer_load_dwordx4 v[80:83], v7, s[24:27], s81 offen offset:3072 sc1
    s_waitcnt lgkmcnt(0)
    s_barrier
    ds_read_b64_tr_b16 v[180:181], v196 offset:8192
    ds_read_b64_tr_b16 v[182:183], v196 offset:9216
    ds_read_b64_tr_b16 v[184:185], v196 offset:8704
    ds_read_b64_tr_b16 v[186:187], v196 offset:9728
    s_waitcnt lgkmcnt(4)
    s_waitcnt vmcnt(8)
    v_mfma_f32_32x32x16_bf16 v[116:131], v[188:191], v[44:47], v[116:131]
    v_mfma_f32_32x32x16_bf16 v[132:147], v[188:191], v[48:51], v[132:147]
    v_mfma_f32_32x32x16_bf16 v[148:163], v[192:195], v[44:47], v[148:163]
    v_mfma_f32_32x32x16_bf16 v[164:179], v[192:195], v[48:51], v[164:179]
    s_add_u32 s80, s80, 4096
    buffer_load_dwordx4 v[84:87], v7, s[24:27], s80 offen offset:0 sc1
    s_add_u32 s81, s81, 4096
    buffer_load_dwordx4 v[88:91], v7, s[24:27], s81 offen offset:0 sc1
    ds_read_b64_tr_b16 v[188:189], v196 offset:10240
    ds_read_b64_tr_b16 v[190:191], v196 offset:11264
    ds_read_b64_tr_b16 v[192:193], v196 offset:10752
    ds_read_b64_tr_b16 v[194:195], v196 offset:11776
    s_waitcnt lgkmcnt(4)
    s_waitcnt vmcnt(8)
    v_mfma_f32_32x32x16_bf16 v[116:131], v[180:183], v[52:55], v[116:131]
    v_mfma_f32_32x32x16_bf16 v[132:147], v[180:183], v[56:59], v[132:147]
    v_mfma_f32_32x32x16_bf16 v[148:163], v[184:187], v[52:55], v[148:163]
    v_mfma_f32_32x32x16_bf16 v[164:179], v[184:187], v[56:59], v[164:179]
    buffer_load_dwordx4 v[92:95], v7, s[24:27], s80 offen offset:1024 sc1
    buffer_load_dwordx4 v[96:99], v7, s[24:27], s81 offen offset:1024 sc1
    ds_read_b64_tr_b16 v[180:181], v196 offset:12288
    ds_read_b64_tr_b16 v[182:183], v196 offset:13312
    ds_read_b64_tr_b16 v[184:185], v196 offset:12800
    ds_read_b64_tr_b16 v[186:187], v196 offset:13824
    s_waitcnt lgkmcnt(4)
    s_waitcnt vmcnt(8)
    v_mfma_f32_32x32x16_bf16 v[116:131], v[188:191], v[60:63], v[116:131]
    v_mfma_f32_32x32x16_bf16 v[132:147], v[188:191], v[64:67], v[132:147]
    v_mfma_f32_32x32x16_bf16 v[148:163], v[192:195], v[60:63], v[148:163]
    v_mfma_f32_32x32x16_bf16 v[164:179], v[192:195], v[64:67], v[164:179]
    buffer_load_dwordx4 v[100:103], v7, s[24:27], s80 offen offset:2048 sc1
    buffer_load_dwordx4 v[104:107], v7, s[24:27], s81 offen offset:2048 sc1
    ds_read_b64_tr_b16 v[188:189], v196 offset:14336
    ds_read_b64_tr_b16 v[190:191], v196 offset:15360
    ds_read_b64_tr_b16 v[192:193], v196 offset:14848
    ds_read_b64_tr_b16 v[194:195], v196 offset:15872
    s_waitcnt lgkmcnt(4)
    s_waitcnt vmcnt(8)
    v_mfma_f32_32x32x16_bf16 v[116:131], v[180:183], v[68:71], v[116:131]
    v_mfma_f32_32x32x16_bf16 v[132:147], v[180:183], v[72:75], v[132:147]
    v_mfma_f32_32x32x16_bf16 v[148:163], v[184:187], v[68:71], v[148:163]
    v_mfma_f32_32x32x16_bf16 v[164:179], v[184:187], v[72:75], v[164:179]
    buffer_load_dwordx4 v[108:111], v7, s[24:27], s80 offen offset:3072 sc1
    buffer_load_dwordx4 v[112:115], v7, s[24:27], s81 offen offset:3072 sc1
    s_waitcnt lgkmcnt(0)
    s_barrier
    ds_read_b64_tr_b16 v[180:181], v196 offset:16384
    ds_read_b64_tr_b16 v[182:183], v196 offset:17408
    ds_read_b64_tr_b16 v[184:185], v196 offset:16896
    ds_read_b64_tr_b16 v[186:187], v196 offset:17920
    s_waitcnt lgkmcnt(4)
    s_waitcnt vmcnt(8)
    v_mfma_f32_32x32x16_bf16 v[116:131], v[188:191], v[76:79], v[116:131]
    v_mfma_f32_32x32x16_bf16 v[132:147], v[188:191], v[80:83], v[132:147]
    v_mfma_f32_32x32x16_bf16 v[148:163], v[192:195], v[76:79], v[148:163]
    v_mfma_f32_32x32x16_bf16 v[164:179], v[192:195], v[80:83], v[164:179]
    s_add_u32 s80, s80, 4096
    buffer_load_dwordx4 v[20:23], v7, s[24:27], s80 offen offset:0 sc1
    s_add_u32 s81, s81, 4096
    buffer_load_dwordx4 v[24:27], v7, s[24:27], s81 offen offset:0 sc1
    ds_read_b64_tr_b16 v[188:189], v196 offset:18432
    ds_read_b64_tr_b16 v[190:191], v196 offset:19456
    ds_read_b64_tr_b16 v[192:193], v196 offset:18944
    ds_read_b64_tr_b16 v[194:195], v196 offset:19968
    s_waitcnt lgkmcnt(4)
    s_waitcnt vmcnt(8)
    v_mfma_f32_32x32x16_bf16 v[116:131], v[180:183], v[84:87], v[116:131]
    v_mfma_f32_32x32x16_bf16 v[132:147], v[180:183], v[88:91], v[132:147]
    v_mfma_f32_32x32x16_bf16 v[148:163], v[184:187], v[84:87], v[148:163]
    v_mfma_f32_32x32x16_bf16 v[164:179], v[184:187], v[88:91], v[164:179]
    buffer_load_dwordx4 v[28:31], v7, s[24:27], s80 offen offset:1024 sc1
    buffer_load_dwordx4 v[32:35], v7, s[24:27], s81 offen offset:1024 sc1
    ds_read_b64_tr_b16 v[180:181], v196 offset:20480
    ds_read_b64_tr_b16 v[182:183], v196 offset:21504
    ds_read_b64_tr_b16 v[184:185], v196 offset:20992
    ds_read_b64_tr_b16 v[186:187], v196 offset:22016
    s_waitcnt lgkmcnt(4)
    s_waitcnt vmcnt(8)
    v_mfma_f32_32x32x16_bf16 v[116:131], v[188:191], v[92:95], v[116:131]
    v_mfma_f32_32x32x16_bf16 v[132:147], v[188:191], v[96:99], v[132:147]
    v_mfma_f32_32x32x16_bf16 v[148:163], v[192:195], v[92:95], v[148:163]
    v_mfma_f32_32x32x16_bf16 v[164:179], v[192:195], v[96:99], v[164:179]
    buffer_load_dwordx4 v[36:39], v7, s[24:27], s80 offen offset:2048 sc1
    buffer_load_dwordx4 v[40:43], v7, s[24:27], s81 offen offset:2048 sc1
    ds_read_b64_tr_b16 v[188:189], v196 offset:22528
    ds_read_b64_tr_b16 v[190:191], v196 offset:23552
    ds_read_b64_tr_b16 v[192:193], v196 offset:23040
    ds_read_b64_tr_b16 v[194:195], v196 offset:24064
    s_waitcnt lgkmcnt(4)
    s_waitcnt vmcnt(8)
    v_mfma_f32_32x32x16_bf16 v[116:131], v[180:183], v[100:103], v[116:131]
    v_mfma_f32_32x32x16_bf16 v[132:147], v[180:183], v[104:107], v[132:147]
    v_mfma_f32_32x32x16_bf16 v[148:163], v[184:187], v[100:103], v[148:163]
    v_mfma_f32_32x32x16_bf16 v[164:179], v[184:187], v[104:107], v[164:179]
    buffer_load_dwordx4 v[44:47], v7, s[24:27], s80 offen offset:3072 sc1
    buffer_load_dwordx4 v[48:51], v7, s[24:27], s81 offen offset:3072 sc1
    s_waitcnt lgkmcnt(0)
    s_barrier
    ds_read_b64_tr_b16 v[180:181], v196 offset:24576
    ds_read_b64_tr_b16 v[182:183], v196 offset:25600
    ds_read_b64_tr_b16 v[184:185], v196 offset:25088
    ds_read_b64_tr_b16 v[186:187], v196 offset:26112
    s_waitcnt lgkmcnt(4)
    s_waitcnt vmcnt(8)
    v_mfma_f32_32x32x16_bf16 v[116:131], v[188:191], v[108:111], v[116:131]
    v_mfma_f32_32x32x16_bf16 v[132:147], v[188:191], v[112:115], v[132:147]
    v_mfma_f32_32x32x16_bf16 v[148:163], v[192:195], v[108:111], v[148:163]
    v_mfma_f32_32x32x16_bf16 v[164:179], v[192:195], v[112:115], v[164:179]
    s_add_u32 s80, s80, 4096
    buffer_load_dwordx4 v[52:55], v7, s[24:27], s80 offen offset:0 sc1
    s_add_u32 s81, s81, 4096
    buffer_load_dwordx4 v[56:59], v7, s[24:27], s81 offen offset:0 sc1
    ds_read_b64_tr_b16 v[188:189], v196 offset:26624
    ds_read_b64_tr_b16 v[190:191], v196 offset:27648
    ds_read_b64_tr_b16 v[192:193], v196 offset:27136
    ds_read_b64_tr_b16 v[194:195], v196 offset:28160
    s_waitcnt lgkmcnt(4)
    s_waitcnt vmcnt(8)
    v_mfma_f32_32x32x16_bf16 v[116:131], v[180:183], v[20:23], v[116:131]
    v_mfma_f32_32x32x16_bf16 v[132:147], v[180:183], v[24:27], v[132:147]
    v_mfma_f32_32x32x16_bf16 v[148:163], v[184:187], v[20:23], v[148:163]
    v_mfma_f32_32x32x16_bf16 v[164:179], v[184:187], v[24:27], v[164:179]
    buffer_load_dwordx4 v[60:63], v7, s[24:27], s80 offen offset:1024 sc1
    buffer_load_dwordx4 v[64:67], v7, s[24:27], s81 offen offset:1024 sc1
    ds_read_b64_tr_b16 v[180:181], v196 offset:28672
    ds_read_b64_tr_b16 v[182:183], v196 offset:29696
    ds_read_b64_tr_b16 v[184:185], v196 offset:29184
    ds_read_b64_tr_b16 v[186:187], v196 offset:30208
    s_waitcnt lgkmcnt(4)
    s_waitcnt vmcnt(8)
    v_mfma_f32_32x32x16_bf16 v[116:131], v[188:191], v[28:31], v[116:131]
    v_mfma_f32_32x32x16_bf16 v[132:147], v[188:191], v[32:35], v[132:147]
    v_mfma_f32_32x32x16_bf16 v[148:163], v[192:195], v[28:31], v[148:163]
    v_mfma_f32_32x32x16_bf16 v[164:179], v[192:195], v[32:35], v[164:179]
    buffer_load_dwordx4 v[68:71], v7, s[24:27], s80 offen offset:2048 sc1
    buffer_load_dwordx4 v[72:75], v7, s[24:27], s81 offen offset:2048 sc1
    ds_read_b64_tr_b16 v[188:189], v196 offset:30720
    ds_read_b64_tr_b16 v[190:191], v196 offset:31744
    ds_read_b64_tr_b16 v[192:193], v196 offset:31232
    ds_read_b64_tr_b16 v[194:195], v196 offset:32256
    s_waitcnt lgkmcnt(4)
    s_waitcnt vmcnt(8)
    v_mfma_f32_32x32x16_bf16 v[116:131], v[180:183], v[36:39], v[116:131]
    v_mfma_f32_32x32x16_bf16 v[132:147], v[180:183], v[40:43], v[132:147]
    v_mfma_f32_32x32x16_bf16 v[148:163], v[184:187], v[36:39], v[148:163]
    v_mfma_f32_32x32x16_bf16 v[164:179], v[184:187], v[40:43], v[164:179]
    buffer_load_dwordx4 v[76:79], v7, s[24:27], s80 offen offset:3072 sc1
    buffer_load_dwordx4 v[80:83], v7, s[24:27], s81 offen offset:3072 sc1
    s_waitcnt lgkmcnt(0)
    s_barrier
    ds_read_b64_tr_b16 v[180:181], v196 offset:0
    ds_read_b64_tr_b16 v[182:183], v196 offset:1024
    ds_read_b64_tr_b16 v[184:185], v196 offset:512
    ds_read_b64_tr_b16 v[186:187], v196 offset:1536
    s_waitcnt lgkmcnt(4)
    s_waitcnt vmcnt(8)
    v_mfma_f32_32x32x16_bf16 v[116:131], v[188:191], v[44:47], v[116:131]
    v_mfma_f32_32x32x16_bf16 v[132:147], v[188:191], v[48:51], v[132:147]
    v_mfma_f32_32x32x16_bf16 v[148:163], v[192:195], v[44:47], v[148:163]
    v_mfma_f32_32x32x16_bf16 v[164:179], v[192:195], v[48:51], v[164:179]
    s_add_u32 s80, s80, 4096
    buffer_load_dwordx4 v[84:87], v7, s[24:27], s80 offen offset:0 sc1
    s_add_u32 s81, s81, 4096
    buffer_load_dwordx4 v[88:91], v7, s[24:27], s81 offen offset:0 sc1
    ds_read_b64_tr_b16 v[188:189], v196 offset:2048
    ds_read_b64_tr_b16 v[190:191], v196 offset:3072
    ds_read_b64_tr_b16 v[192:193], v196 offset:2560
    ds_read_b64_tr_b16 v[194:195], v196 offset:3584
    s_waitcnt lgkmcnt(4)
    s_waitcnt vmcnt(8)
    v_mfma_f32_32x32x16_bf16 v[116:131], v[180:183], v[52:55], v[116:131]
    v_mfma_f32_32x32x16_bf16 v[132:147], v[180:183], v[56:59], v[132:147]
    v_mfma_f32_32x32x16_bf16 v[148:163], v[184:187], v[52:55], v[148:163]
    v_mfma_f32_32x32x16_bf16 v[164:179], v[184:187], v[56:59], v[164:179]
    buffer_load_dwordx4 v[92:95], v7, s[24:27], s80 offen offset:1024 sc1
    buffer_load_dwordx4 v[96:99], v7, s[24:27], s81 offen offset:1024 sc1
    ds_read_b64_tr_b16 v[180:181], v196 offset:4096
    ds_read_b64_tr_b16 v[182:183], v196 offset:5120
    ds_read_b64_tr_b16 v[184:185], v196 offset:4608
    ds_read_b64_tr_b16 v[186:187], v196 offset:5632
    s_waitcnt lgkmcnt(4)
    s_waitcnt vmcnt(8)
    v_mfma_f32_32x32x16_bf16 v[116:131], v[188:191], v[60:63], v[116:131]
    v_mfma_f32_32x32x16_bf16 v[132:147], v[188:191], v[64:67], v[132:147]
    v_mfma_f32_32x32x16_bf16 v[148:163], v[192:195], v[60:63], v[148:163]
    v_mfma_f32_32x32x16_bf16 v[164:179], v[192:195], v[64:67], v[164:179]
    buffer_load_dwordx4 v[100:103], v7, s[24:27], s80 offen offset:2048 sc1
    buffer_load_dwordx4 v[104:107], v7, s[24:27], s81 offen offset:2048 sc1
    ds_read_b64_tr_b16 v[188:189], v196 offset:6144
    ds_read_b64_tr_b16 v[190:191], v196 offset:7168
    ds_read_b64_tr_b16 v[192:193], v196 offset:6656
    ds_read_b64_tr_b16 v[194:195], v196 offset:7680
    s_waitcnt lgkmcnt(4)
    s_waitcnt vmcnt(8)
    v_mfma_f32_32x32x16_bf16 v[116:131], v[180:183], v[68:71], v[116:131]
    v_mfma_f32_32x32x16_bf16 v[132:147], v[180:183], v[72:75], v[132:147]
    v_mfma_f32_32x32x16_bf16 v[148:163], v[184:187], v[68:71], v[148:163]
    v_mfma_f32_32x32x16_bf16 v[164:179], v[184:187], v[72:75], v[164:179]
    buffer_load_dwordx4 v[108:111], v7, s[24:27], s80 offen offset:3072 sc1
    buffer_load_dwordx4 v[112:115], v7, s[24:27], s81 offen offset:3072 sc1
    s_waitcnt lgkmcnt(0)
    s_barrier
    ds_read_b64_tr_b16 v[180:181], v196 offset:8192
    ds_read_b64_tr_b16 v[182:183], v196 offset:9216
    ds_read_b64_tr_b16 v[184:185], v196 offset:8704
    ds_read_b64_tr_b16 v[186:187], v196 offset:9728
    s_waitcnt lgkmcnt(4)
    s_waitcnt vmcnt(8)
    v_mfma_f32_32x32x16_bf16 v[116:131], v[188:191], v[76:79], v[116:131]
    v_mfma_f32_32x32x16_bf16 v[132:147], v[188:191], v[80:83], v[132:147]
    v_mfma_f32_32x32x16_bf16 v[148:163], v[192:195], v[76:79], v[148:163]
    v_mfma_f32_32x32x16_bf16 v[164:179], v[192:195], v[80:83], v[164:179]
    s_add_u32 s80, s80, 4096
    buffer_load_dwordx4 v[20:23], v7, s[24:27], s80 offen offset:0 sc1
    s_add_u32 s81, s81, 4096
    buffer_load_dwordx4 v[24:27], v7, s[24:27], s81 offen offset:0 sc1
    ds_read_b64_tr_b16 v[188:189], v196 offset:10240
    ds_read_b64_tr_b16 v[190:191], v196 offset:11264
    ds_read_b64_tr_b16 v[192:193], v196 offset:10752
    ds_read_b64_tr_b16 v[194:195], v196 offset:11776
    s_waitcnt lgkmcnt(4)
    s_waitcnt vmcnt(8)
    v_mfma_f32_32x32x16_bf16 v[116:131], v[180:183], v[84:87], v[116:131]
    v_mfma_f32_32x32x16_bf16 v[132:147], v[180:183], v[88:91], v[132:147]
    v_mfma_f32_32x32x16_bf16 v[148:163], v[184:187], v[84:87], v[148:163]
    v_mfma_f32_32x32x16_bf16 v[164:179], v[184:187], v[88:91], v[164:179]
    buffer_load_dwordx4 v[28:31], v7, s[24:27], s80 offen offset:1024 sc1
    buffer_load_dwordx4 v[32:35], v7, s[24:27], s81 offen offset:1024 sc1
    ds_read_b64_tr_b16 v[180:181], v196 offset:12288
    ds_read_b64_tr_b16 v[182:183], v196 offset:13312
    ds_read_b64_tr_b16 v[184:185], v196 offset:12800
    ds_read_b64_tr_b16 v[186:187], v196 offset:13824
    s_waitcnt lgkmcnt(4)
    s_waitcnt vmcnt(8)
    v_mfma_f32_32x32x16_bf16 v[116:131], v[188:191], v[92:95], v[116:131]
    v_mfma_f32_32x32x16_bf16 v[132:147], v[188:191], v[96:99], v[132:147]
    v_mfma_f32_32x32x16_bf16 v[148:163], v[192:195], v[92:95], v[148:163]
    v_mfma_f32_32x32x16_bf16 v[164:179], v[192:195], v[96:99], v[164:179]
    buffer_load_dwordx4 v[36:39], v7, s[24:27], s80 offen offset:2048 sc1
    buffer_load_dwordx4 v[40:43], v7, s[24:27], s81 offen offset:2048 sc1
    ds_read_b64_tr_b16 v[188:189], v196 offset:14336
    ds_read_b64_tr_b16 v[190:191], v196 offset:15360
    ds_read_b64_tr_b16 v[192:193], v196 offset:14848
    ds_read_b64_tr_b16 v[194:195], v196 offset:15872
    s_waitcnt lgkmcnt(4)
    s_waitcnt vmcnt(8)
    v_mfma_f32_32x32x16_bf16 v[116:131], v[180:183], v[100:103], v[116:131]
    v_mfma_f32_32x32x16_bf16 v[132:147], v[180:183], v[104:107], v[132:147]
    v_mfma_f32_32x32x16_bf16 v[148:163], v[184:187], v[100:103], v[148:163]
    v_mfma_f32_32x32x16_bf16 v[164:179], v[184:187], v[104:107], v[164:179]
    buffer_load_dwordx4 v[44:47], v7, s[24:27], s80 offen offset:3072 sc1
    buffer_load_dwordx4 v[48:51], v7, s[24:27], s81 offen offset:3072 sc1
    s_waitcnt lgkmcnt(0)
    s_barrier
    ds_read_b64_tr_b16 v[180:181], v196 offset:16384
    ds_read_b64_tr_b16 v[182:183], v196 offset:17408
    ds_read_b64_tr_b16 v[184:185], v196 offset:16896
    ds_read_b64_tr_b16 v[186:187], v196 offset:17920
    s_waitcnt lgkmcnt(4)
    s_waitcnt vmcnt(8)
    v_mfma_f32_32x32x16_bf16 v[116:131], v[188:191], v[108:111], v[116:131]
    v_mfma_f32_32x32x16_bf16 v[132:147], v[188:191], v[112:115], v[132:147]
    v_mfma_f32_32x32x16_bf16 v[148:163], v[192:195], v[108:111], v[148:163]
    v_mfma_f32_32x32x16_bf16 v[164:179], v[192:195], v[112:115], v[164:179]
    ds_read_b64_tr_b16 v[188:189], v196 offset:18432
    ds_read_b64_tr_b16 v[190:191], v196 offset:19456
    ds_read_b64_tr_b16 v[192:193], v196 offset:18944
    ds_read_b64_tr_b16 v[194:195], v196 offset:19968
    s_waitcnt lgkmcnt(4)
    s_waitcnt vmcnt(6)
    v_mfma_f32_32x32x16_bf16 v[116:131], v[180:183], v[20:23], v[116:131]
    v_mfma_f32_32x32x16_bf16 v[132:147], v[180:183], v[24:27], v[132:147]
    v_mfma_f32_32x32x16_bf16 v[148:163], v[184:187], v[20:23], v[148:163]
    v_mfma_f32_32x32x16_bf16 v[164:179], v[184:187], v[24:27], v[164:179]
    ds_read_b64_tr_b16 v[180:181], v196 offset:20480
    ds_read_b64_tr_b16 v[182:183], v196 offset:21504
    ds_read_b64_tr_b16 v[184:185], v196 offset:20992
    ds_read_b64_tr_b16 v[186:187], v196 offset:22016
    s_waitcnt lgkmcnt(4)
    s_waitcnt vmcnt(4)
    v_mfma_f32_32x32x16_bf16 v[116:131], v[188:191], v[28:31], v[116:131]
    v_mfma_f32_32x32x16_bf16 v[132:147], v[188:191], v[32:35], v[132:147]
    v_mfma_f32_32x32x16_bf16 v[148:163], v[192:195], v[28:31], v[148:163]
    v_mfma_f32_32x32x16_bf16 v[164:179], v[192:195], v[32:35], v[164:179]
    ds_read_b64_tr_b16 v[188:189], v196 offset:22528
    ds_read_b64_tr_b16 v[190:191], v196 offset:23552
    ds_read_b64_tr_b16 v[192:193], v196 offset:23040
    ds_read_b64_tr_b16 v[194:195], v196 offset:24064
    s_waitcnt lgkmcnt(4)
    s_waitcnt vmcnt(2)
    v_mfma_f32_32x32x16_bf16 v[116:131], v[180:183], v[36:39], v[116:131]
    v_mfma_f32_32x32x16_bf16 v[132:147], v[180:183], v[40:43], v[132:147]
    v_mfma_f32_32x32x16_bf16 v[148:163], v[184:187], v[36:39], v[148:163]
    v_mfma_f32_32x32x16_bf16 v[164:179], v[184:187], v[40:43], v[164:179]
    s_waitcnt lgkmcnt(0)
    s_waitcnt vmcnt(0)
    v_mfma_f32_32x32x16_bf16 v[116:131], v[188:191], v[44:47], v[116:131]
    v_mfma_f32_32x32x16_bf16 v[132:147], v[188:191], v[48:51], v[132:147]
    v_mfma_f32_32x32x16_bf16 v[148:163], v[192:195], v[44:47], v[148:163]
    v_mfma_f32_32x32x16_bf16 v[164:179], v[192:195], v[48:51], v[164:179]
    s_barrier
    s_lshl_b32 s40, s37, 12
    s_add_u32 s40, s40, 0
    v_add_u32 v2, s40, v7
    s_nop 4
    ds_write_b128 v2, v[116:119] offset:0
    ds_write_b128 v2, v[120:123] offset:1024
    ds_write_b128 v2, v[124:127] offset:2048
    ds_write_b128 v2, v[128:131] offset:3072
    ds_write_b128 v2, v[132:135] offset:16384
    ds_write_b128 v2, v[136:139] offset:17408
    ds_write_b128 v2, v[140:143] offset:18432
    ds_write_b128 v2, v[144:147] offset:19456
    ds_write_b128 v2, v[148:151] offset:32768
    ds_write_b128 v2, v[152:155] offset:33792
    ds_write_b128 v2, v[156:159] offset:34816
    ds_write_b128 v2, v[160:163] offset:35840
    ds_write_b128 v2, v[164:167] offset:49152
    ds_write_b128 v2, v[168:171] offset:50176
    ds_write_b128 v2, v[172:175] offset:51200
    ds_write_b128 v2, v[176:179] offset:52224
    s_waitcnt lgkmcnt(0)
KM_Z:
    s_barrier
    s_lshl_b32 s40, s37, 14
    s_lshl_b32 s41, s56, 11
    s_add_u32 s40, s40, s41
    s_add_u32 s40, s40, 0
    v_add_u32 v2, s40, v7
    ds_read_b128 v[20:23], v2 offset:0
    ds_read_b128 v[24:27], v2 offset:1024
    ds_read_b128 v[28:31], v2 offset:4096
    ds_read_b128 v[32:35], v2 offset:5120
    ds_read_b128 v[36:39], v2 offset:8192
    ds_read_b128 v[40:43], v2 offset:9216
    ds_read_b128 v[44:47], v2 offset:12288
    ds_read_b128 v[48:51], v2 offset:13312
    s_waitcnt lgkmcnt(4)
    v_add_f32 v20, v20, v28
    v_add_f32 v21, v21, v29
    v_add_f32 v22, v22, v30
    v_add_f32 v23, v23, v31
    v_add_f32 v24, v24, v32
    v_add_f32 v25, v25, v33
    v_add_f32 v26, v26, v34
    v_add_f32 v27, v27, v35
    s_waitcnt lgkmcnt(0)
    v_add_f32 v36, v36, v44
    v_add_f32 v37, v37, v45
    v_add_f32 v38, v38, v46
    v_add_f32 v39, v39, v47
    v_add_f32 v40, v40, v48
    v_add_f32 v41, v41, v49
    v_add_f32 v42, v42, v50
    v_add_f32 v43, v43, v51
    v_add_f32 v20, v20, v36
    v_add_f32 v21, v21, v37
    v_add_f32 v22, v22, v38
    v_add_f32 v23, v23, v39
    v_add_f32 v24, v24, v40
    v_add_f32 v25, v25, v41
    v_add_f32 v26, v26, v42
    v_add_f32 v27, v27, v43
    v_lshlrev_b32 v116, 16, v8
    v_and_b32 v117, 0xffff0000, v8
    v_lshlrev_b32 v118, 16, v9
    v_and_b32 v119, 0xffff0000, v9
    v_lshlrev_b32 v120, 16, v10
    v_and_b32 v121, 0xffff0000, v10
    v_lshlrev_b32 v122, 16, v11
    v_and_b32 v123, 0xffff0000, v11
    v_add_f32 v20, v20, v116
    v_add_f32 v21, v21, v117
    v_add_f32 v22, v22, v118
    v_add_f32 v23, v23, v119
    v_add_f32 v24, v24, v120
    v_add_f32 v25, v25, v121
    v_add_f32 v26, v26, v122
    v_add_f32 v27, v27, v123
    s_waitcnt vmcnt(0)
    v_lshlrev_b32 v116, 16, v200
    v_and_b32 v117, 0xffff0000, v200
    v_lshlrev_b32 v118, 16, v201
    v_and_b32 v119, 0xffff0000, v201
    v_lshlrev_b32 v120, 16, v202
    v_and_b32 v121, 0xffff0000, v202
    v_lshlrev_b32 v122, 16, v203
    v_and_b32 v123, 0xffff0000, v203
    v_add_f32 v20, v20, v116
    v_add_f32 v21, v21, v117
    v_add_f32 v22, v22, v118
    v_add_f32 v23, v23, v119
    v_add_f32 v24, v24, v120
    v_add_f32 v25, v25, v121
    v_add_f32 v26, v26, v122
    v_add_f32 v27, v27, v123
    v_cvt_pk_bf16_f32 v132, v20, v21
    v_cvt_pk_bf16_f32 v133, v22, v23
    v_cvt_pk_bf16_f32 v134, v24, v25
    v_cvt_pk_bf16_f32 v135, v26, v27
    s_nop 0
    v_permlane32_swap_b32 v132, v134
    v_permlane32_swap_b32 v133, v135
    s_lshl_b32 s40, s50, 16
    s_lshl_b32 s41, s55, 15
    s_add_u32 s40, s40, s41
    s_lshl_b32 s41, s51, 7
    s_add_u32 s40, s40, s41
    s_lshl_b32 s41, s54, 6
    s_add_u32 s40, s40, s41
    s_lshl_b32 s41, s56, 5
    s_add_u32 s40, s40, s41
    v_lshlrev_b32 v2, 10, v6
    v_lshl_add_u32 v2, v5, 4, v2
    buffer_store_dwordx4 v[132:135], v2, s[32:35], s40 offen
KM_END:
    s_endpgm
.section .rodata,"a"
.p2align 6
.amdhsa_kernel k1_qkv_kernel
  .amdhsa_next_free_vgpr 162
  .amdhsa_next_free_sgpr 66
  .amdhsa_accum_offset 164
  .amdhsa_group_segment_fixed_size 0
  .amdhsa_kernarg_size 88
  .amdhsa_user_sgpr_count 2
  .amdhsa_user_sgpr_kernarg_segment_ptr 1
  .amdhsa_system_sgpr_workgroup_id_x 1
.end_amdhsa_kernel
.p2align 6
.amdhsa_kernel km_fused_kernel
  .amdhsa_next_free_vgpr 205
  .amdhsa_next_free_sgpr 82
  .amdhsa_accum_offset 208
  .amdhsa_group_segment_fixed_size 0
  .amdhsa_kernarg_size 88
  .amdhsa_user_sgpr_count 2
  .amdhsa_user_sgpr_kernarg_segment_ptr 1
  .amdhsa_system_sgpr_workgroup_id_x 1
.end_amdhsa_kernel
```
